```python
import torch

def _softmax(x, axis=-1):
    return torch.softmax(x, dim=axis)
def _gelu(x):
    return torch.nn.functional.gelu(x, approximate="tanh")
def _silu(x):
    return torch.nn.functional.silu(x)
def _sigmoid(x):
    return torch.sigmoid(x)
def _layernorm(x, axis=-1, eps=1e-5):
    m = x.mean(dim=axis, keepdim=True)
    v = x.var(dim=axis, keepdim=True, unbiased=False)
    return (x - m) / torch.sqrt(v + eps)
def _scatter_add(tgt, idx, src, axis=0):
    return tgt.clone().index_add_(axis, idx, src)
def _segment_sum(src, seg, n):
    out = torch.zeros((n,) + src.shape[1:], dtype=src.dtype)
    return out.index_add_(0, seg, src)
def _pad(x, pw):
    flat = tuple(v for pair in reversed(pw) for v in pair)
    return torch.nn.functional.pad(x, flat)

kernel_name = 'gated_mix__spectral_gfnet__dense_activation_gelu__prompt'

def setup_inputs():

    _w = (lambda a: (lambda t: t.to(torch.bfloat16) if t.is_floating_point() else t)(torch.as_tensor(a)))
    def _A_setup():
        B, S, D = 1, 2048, 448
        Df = D // 2 + 1
        return {
            "x": _w((lambda *s: torch.randn(*s, dtype=torch.bfloat16) * 0.05)(B, S, D)),
            "w_r": _w((lambda *s: torch.randn(*s, dtype=torch.bfloat16) * 0.8)(S, Df) * 0.02),
            "w_i": _w((lambda *s: torch.randn(*s, dtype=torch.bfloat16) * 0.8)(S, Df) * 0.02),
        }
    _A_in = _A_setup()

    def _B_setup():
        B, S, D, F = 1, 2048, 448, 1792
        return {
            "x": _w((lambda *s: torch.randn(*s, dtype=torch.bfloat16) * 0.05)(B, S, D)),
            "w1": _w((lambda *s: torch.randn(*s, dtype=torch.bfloat16) * 3.2)(D, F) * (D ** -0.5)),
            "b1": _w((lambda *s: torch.randn(*s, dtype=torch.bfloat16) * 3.2)(F) * 0.01),
            "w2": _w((lambda *s: torch.randn(*s, dtype=torch.bfloat16) * 0.05)(F, D) * (F ** -0.5)),
            "b2": _w((lambda *s: torch.randn(*s, dtype=torch.bfloat16) * 0.1)(D) * 0.01),
        }
    _B_in = _B_setup()

    return {
        "A_x": _A_in["x"],
        "A_w_r": _A_in["w_r"],
        "A_w_i": _A_in["w_i"],
        "B_x": _B_in["x"],
        "B_w1": _B_in["w1"],
        "B_b1": _B_in["b1"],
        "B_w2": _B_in["w2"],
        "B_b2": _B_in["b2"],
        "gate_w": _w((lambda *s: torch.randn(*s, dtype=torch.bfloat16) * 0.05)(448) * 16.0),
    }

def reference(A_x, A_w_r, A_w_i, B_x, B_w1, B_b1, B_w2, B_b2, gate_w):
    def _A_ref(x, w_r, w_i):
        B, S, D = x.shape
        X = (lambda x, axes=(-2,-1): torch.fft.rfft2(x.float(), dim=axes))(x, axes=(-2, -1))
        W = w_r + 1j * w_i
        X = X * W
        y = (lambda x, s, axes=(-2,-1): torch.fft.irfft2(x, s=s, dim=axes).to(torch.bfloat16))(X, (S, D), axes=(-2, -1))
        return y

    def _B_ref(x, w1, b1, w2, b2):
        h = torch.einsum("bsd,df->bsf", x, w1) + b1
        h = _gelu(h)
        return torch.einsum("bsf,fd->bsd", h, w2) + b2

    x = A_x
    g = _sigmoid((x * gate_w).sum(-1, keepdims=True))
    a = _A_ref(x, A_w_r, A_w_i)
    b = _B_ref(x, B_w1, B_b1, B_w2, B_b2)
    return g * a + (1 - g) * b
```

```asm
; @launch grid=(256,1,1) block=(512,1,1) lds=163840
.amdgcn_target "amdgcn-amd-amdhsa--gfx950"
.text
.globl gated_mix__spectral_gfnet__dense_activation_gelu__prompt_kernel
.p2align 8
.type gated_mix__spectral_gfnet__dense_activation_gelu__prompt_kernel,@function
gated_mix__spectral_gfnet__dense_activation_gelu__prompt_kernel:
    s_cmp_ge_u32 s2, 256
    s_cbranch_scc1 K_END
    s_load_dwordx2 s[4:5], s[0:1], 0
    s_load_dwordx4 s[8:11], s[0:1], 32
    s_load_dwordx2 s[12:13], s[0:1], 88
    s_getpc_b64 s[84:85]
K_PC:
    v_lshlrev_b32 v2, 6, v0
    v_min_u32 v2, K_END-K_PC, v2
    v_mov_b32 v3, s85
    v_add_co_u32 v2, vcc, s84, v2
    s_nop 1
    v_addc_co_u32 v3, vcc, 0, v3, vcc
    global_load_dword v5, v[2:3], off
K_NOPF:
    s_load_dwordx4 s[60:63], s[0:1], 48
    s_load_dwordx2 s[6:7], s[0:1], 72
    s_load_dwordx2 s[86:87], s[0:1], 64
    v_lshrrev_b32 v2, 6, v0
    v_and_b32 v1, 63, v0
    v_readfirstlane_b32 s100, v2
    v_and_b32 v2, 3, v2
    s_and_b32 s41, s2, 7
    s_lshr_b32 s42, s2, 3
    s_mul_i32 s3, s42, 37
    s_lshr_b32 s3, s3, 8
    s_mul_i32 s15, s3, 7
    s_sub_u32 s15, s42, s15
    s_lshr_b32 s43, s41, 1
    s_lshl_b32 s43, s43, 2
    s_add_u32 s43, s43, s3
    s_and_b32 s44, s41, 1
    s_mul_i32 s44, s44, 7
    s_add_u32 s44, s44, s15
    s_and_b32 s40, s100, 3
    s_lshl_b32 s47, s44, 8
    s_lshl_b32 s48, s40, 12
    s_lshl_b32 s49, s40, 11
    s_cmp_ge_u32 s42, 28
    s_cbranch_scc1 K_HELP
    s_cmp_lt_u32 s100, 4
    s_cbranch_scc1 K_G0
K_G1:
    s_lshr_b32 s88, s41, 1
    s_and_b32 s95, s41, 1
    s_lshl_b32 s95, s95, 1
    s_add_u32 s88, s88, s95
    s_lshr_b32 s95, s15, 2
    s_add_u32 s88, s88, s95
    s_and_b32 s88, s88, 3
    s_lshl_b32 s88, s88, 1
    s_cmp_ge_u32 s88, 7
    s_cselect_b32 s95, 7, 0
    s_sub_u32 s88, s88, s95
    v_and_b32 v4, 7, v1
    v_bfe_u32 v3, v1, 4, 1
    v_lshlrev_b32 v3, 2, v3
    v_xor_b32 v4, v4, v3
    v_lshlrev_b32 v4, 4, v4
    v_lshrrev_b32 v3, 3, v1
    v_mul_u32_u24 v6, 896, v3
    v_add_u32 v6, v6, v4
    v_xor_b32 v7, 16, v6
    v_add_u32 v7, 27648, v7
    v_xor_b32 v8, 32, v6
    v_add_u32 v8, 55296, v8
    v_xor_b32 v9, 48, v6
    v_add_u32 v9, 82944, v9
    s_lshl_b32 s45, s43, 7
    s_lshl_b32 s46, s40, 3
    s_add_u32 s45, s45, s46
    s_mul_i32 s45, s45, 896
    s_waitcnt lgkmcnt(0)
    s_mov_b32 s16, s4
    s_mov_b32 s17, s5
    s_mov_b32 s18, 1835008
    s_mov_b32 s19, 0x20000
    s_add_u32 m0, s48, 0
    s_lshl_b32 s50, s88, 7
    s_add_u32 s50, s50, s45
    buffer_load_dwordx4 v6, s[16:19], s50 offen offset:0 lds
    buffer_load_dwordx4 v7, s[16:19], s50 offen offset:1024 lds
    buffer_load_dwordx4 v8, s[16:19], s50 offen offset:2048 lds
    buffer_load_dwordx4 v9, s[16:19], s50 offen offset:3072 lds
    s_waitcnt lgkmcnt(0)
    s_add_u32 s36, s12, 7340032
    s_addc_u32 s37, s13, 0
    s_add_u32 s89, s88, 1
    s_cmp_ge_u32 s89, 7
    s_cselect_b32 s95, 7, 0
    s_sub_u32 s89, s89, s95
    s_add_u32 s90, s89, 1
    s_cmp_ge_u32 s90, 7
    s_cselect_b32 s95, 7, 0
    s_sub_u32 s90, s90, s95
    s_add_u32 s91, s90, 1
    s_cmp_ge_u32 s91, 7
    s_cselect_b32 s95, 7, 0
    s_sub_u32 s91, s91, s95
    s_add_u32 s92, s91, 1
    s_cmp_ge_u32 s92, 7
    s_cselect_b32 s95, 7, 0
    s_sub_u32 s92, s92, s95
    s_add_u32 s93, s92, 1
    s_cmp_ge_u32 s93, 7
    s_cselect_b32 s95, 7, 0
    s_sub_u32 s93, s93, s95
    s_add_u32 s94, s93, 1
    s_cmp_ge_u32 s94, 7
    s_cselect_b32 s95, 7, 0
    s_sub_u32 s94, s94, s95
    v_mul_u32_u24 v40, 3584, v3
    v_add_u32 v40, v40, v4
    v_add_u32 v41, 27648, v40
    s_mul_i32 s46, s40, 57344
    s_add_u32 s46, s46, s47
    s_mov_b32 s20, s8
    s_mov_b32 s21, s9
    s_mov_b32 s22, 1605632
    s_mov_b32 s23, 0x20000
    s_mov_b32 s24, s86
    s_mov_b32 s25, s87
    s_mov_b32 s26, 896
    s_mov_b32 s27, 0x20000
    v_add_u32 v3, s88, v3
    v_subrev_u32 v4, 7, v3
    v_min_u32 v3, v3, v4
    v_and_b32 v4, 7, v1
    v_lshlrev_b32 v4, 4, v4
    v_lshl_add_u32 v3, v3, 7, v4
    s_add_u32 m0, s49, 155648
    s_nop 0
    buffer_load_dwordx4 v3, s[24:27], 0 offen lds
    s_add_u32 m0, s48, 16384
    s_lshl_b32 s50, s89, 7
    s_add_u32 s50, s50, s45
    buffer_load_dwordx4 v6, s[16:19], s50 offen offset:0 lds
    buffer_load_dwordx4 v7, s[16:19], s50 offen offset:1024 lds
    buffer_load_dwordx4 v8, s[16:19], s50 offen offset:2048 lds
    buffer_load_dwordx4 v9, s[16:19], s50 offen offset:3072 lds
    s_add_u32 m0, s48, 32768
    s_lshl_b32 s50, s90, 7
    s_add_u32 s50, s50, s45
    buffer_load_dwordx4 v6, s[16:19], s50 offen offset:0 lds
    buffer_load_dwordx4 v7, s[16:19], s50 offen offset:1024 lds
    buffer_load_dwordx4 v8, s[16:19], s50 offen offset:2048 lds
    buffer_load_dwordx4 v9, s[16:19], s50 offen offset:3072 lds
    v_lshlrev_b32 v10, 4, v1
    v_mov_b32 v11, 0
    v_mov_b32 v15, 0
    v_and_b32 v12, 31, v1
    v_lshrrev_b32 v14, 5, v1
    v_add_u32 v42, 81920, v10
    s_barrier
    ds_read_b128 a[80:83], v42 offset:0
    ds_read_b128 a[84:87], v42 offset:1024
    ds_read_b128 a[88:91], v42 offset:2048
    ds_read_b128 a[92:95], v42 offset:3072
    ds_read_b128 a[96:99], v42 offset:4096
    ds_read_b128 a[100:103], v42 offset:5120
    ds_read_b128 a[104:107], v42 offset:6144
    ds_read_b128 a[108:111], v42 offset:7168
    ds_read_b128 v[64:67], v42 offset:8192
    ds_read_b128 v[68:71], v42 offset:9216
    ds_read_b128 v[72:75], v42 offset:10240
    ds_read_b128 v[76:79], v42 offset:11264
    ds_read_b128 v[80:83], v42 offset:12288
    ds_read_b128 v[84:87], v42 offset:13312
    ds_read_b128 v[88:91], v42 offset:14336
    ds_read_b128 v[92:95], v42 offset:15360
    ds_read_b128 v[96:99], v42 offset:16384
    ds_read_b128 v[100:103], v42 offset:17408
    ds_read_b128 v[104:107], v42 offset:18432
    ds_read_b128 v[108:111], v42 offset:19456
    ds_read_b128 v[112:115], v42 offset:20480
    ds_read_b128 v[116:119], v42 offset:21504
    ds_read_b128 v[120:123], v42 offset:22528
    ds_read_b128 v[124:127], v42 offset:23552
    ds_read_b128 v[128:131], v42 offset:24576
    ds_read_b128 v[132:135], v42 offset:25600
    ds_read_b128 v[136:139], v42 offset:26624
    ds_read_b128 v[140:143], v42 offset:27648
    s_add_u32 m0, s48, 49152
    s_lshl_b32 s50, s91, 7
    s_add_u32 s50, s50, s45
    buffer_load_dwordx4 v6, s[16:19], s50 offen offset:0 lds
    buffer_load_dwordx4 v7, s[16:19], s50 offen offset:1024 lds
    buffer_load_dwordx4 v8, s[16:19], s50 offen offset:2048 lds
    buffer_load_dwordx4 v9, s[16:19], s50 offen offset:3072 lds
    s_mov_b32 s38, 1048576
    s_mov_b32 s39, 0x20000
    s_add_u32 s28, s12, 8388608
    s_addc_u32 s29, s13, 0
    s_mov_b32 s30, 7340032
    s_mov_b32 s31, 0x20000
    s_mov_b32 s32, s12
    s_mov_b32 s33, s13
    s_mov_b32 s34, 1835008
    s_mov_b32 s35, 0x20000
    s_mov_b32 s64, s60
    s_mov_b32 s65, s61
    s_mov_b32 s66, 1605632
    s_mov_b32 s67, 0x20000
    s_add_u32 s68, s12, 2097152
    s_addc_u32 s69, s13, 0
    s_mov_b32 s70, 1843200
    s_mov_b32 s71, 0x20000
    s_add_u32 s72, s12, 4194304
    s_addc_u32 s73, s13, 0
    s_mov_b32 s74, 1843200
    s_mov_b32 s75, 0x20000
    s_add_u32 s76, s12, 6291456
    s_addc_u32 s77, s13, 0
    s_mov_b32 s78, 229376
    s_mov_b32 s79, 0x20000
    s_mov_b32 s80, s6
    s_mov_b32 s81, s7
    s_mov_b32 s82, 1835008
    s_mov_b32 s83, 0x20000
    v_and_b32 v16, 3, v12
    v_lshrrev_b32 v3, 2, v12
    v_lshl_add_u32 v4, v16, 3, v3
    v_bfe_u32 v17, v12, 3, 1
    v_lshl_add_u32 v17, v17, 2, v16
    v_xor_b32 v17, v17, v14
    v_lshlrev_b32 v17, 4, v17
    v_lshl_add_u32 v32, v4, 7, v17
    v_add_u32 v32, s48, v32
    v_xor_b32 v33, 32, v32
    v_xor_b32 v34, 64, v32
    v_xor_b32 v35, 96, v32
    v_and_b32 v36, 15, v1
    v_lshlrev_b32 v36, 13, v36
    v_bfe_u32 v3, v1, 4, 1
    v_lshl_add_u32 v36, v3, 5, v36
    v_lshl_add_u32 v36, v14, 4, v36
    s_lshl_b32 s53, s43, 2
    s_add_u32 s53, s53, s40
    s_lshl_b32 s55, s44, 17
    s_lshl_b32 s56, s53, 7
    s_add_u32 s55, s55, s56
    s_waitcnt lgkmcnt(0)
    s_barrier
    v_lshlrev_b32 v37, 4, v14
    v_add_u32 v37, 155648, v37
    v_add_u32 v37, s49, v37
    s_waitcnt vmcnt(13)
    ds_read_b128 a[0:3], v32 offset:0
    ds_read_b128 a[4:7], v33 offset:0
    ds_read_b128 a[8:11], v34 offset:0
    ds_read_b128 a[12:15], v35 offset:0
    s_add_u32 m0, s48, 65536
    s_lshl_b32 s50, s92, 7
    s_add_u32 s50, s50, s45
    buffer_load_dwordx4 v6, s[16:19], s50 offen offset:0 lds
    buffer_load_dwordx4 v7, s[16:19], s50 offen offset:1024 lds
    buffer_load_dwordx4 v8, s[16:19], s50 offen offset:2048 lds
    buffer_load_dwordx4 v9, s[16:19], s50 offen offset:3072 lds
    s_waitcnt vmcnt(12)
    ds_read_b128 a[16:19], v32 offset:16384
    ds_read_b128 a[20:23], v33 offset:16384
    ds_read_b128 a[24:27], v34 offset:16384
    ds_read_b128 a[28:31], v35 offset:16384
    s_waitcnt lgkmcnt(4)
    v_mfma_f32_32x32x16_bf16 v[16:31], a[0:3], a[80:83], 0
    ds_read_b128 a[80:83], v37 offset:0
    v_mfma_f32_32x32x16_bf16 v[16:31], a[4:7], a[84:87], v[16:31]
    ds_read_b128 a[84:87], v37 offset:32
    v_mfma_f32_32x32x16_bf16 v[16:31], a[8:11], a[88:91], v[16:31]
    ds_read_b128 a[88:91], v37 offset:64
    v_mfma_f32_32x32x16_bf16 v[16:31], a[12:15], a[92:95], v[16:31]
    ds_read_b128 a[92:95], v37 offset:96
    s_add_u32 m0, s48, 81920
    s_lshl_b32 s50, s93, 7
    s_add_u32 s50, s50, s45
    buffer_load_dwordx4 v6, s[16:19], s50 offen offset:0 lds
    buffer_load_dwordx4 v7, s[16:19], s50 offen offset:1024 lds
    buffer_load_dwordx4 v8, s[16:19], s50 offen offset:2048 lds
    buffer_load_dwordx4 v9, s[16:19], s50 offen offset:3072 lds
    s_waitcnt vmcnt(12)
    ds_read_b128 a[32:35], v32 offset:32768
    ds_read_b128 a[36:39], v33 offset:32768
    ds_read_b128 a[40:43], v34 offset:32768
    ds_read_b128 a[44:47], v35 offset:32768
    s_waitcnt lgkmcnt(8)
    v_mfma_f32_32x32x16_bf16 v[16:31], a[16:19], a[96:99], v[16:31]
    ds_read_b128 a[96:99], v37 offset:128
    v_mfma_f32_32x32x16_bf16 v[16:31], a[20:23], a[100:103], v[16:31]
    ds_read_b128 a[100:103], v37 offset:160
    v_mfma_f32_32x32x16_bf16 v[16:31], a[24:27], a[104:107], v[16:31]
    ds_read_b128 a[104:107], v37 offset:192
    v_mfma_f32_32x32x16_bf16 v[16:31], a[28:31], a[108:111], v[16:31]
    ds_read_b128 a[108:111], v37 offset:224
    s_waitcnt lgkmcnt(8)
    v_mfma_f32_32x32x16_bf16 v[48:63], a[80:83], a[0:3], 0
    v_mfma_f32_32x32x16_bf16 v[48:63], a[84:87], a[4:7], v[48:63]
    v_mfma_f32_32x32x16_bf16 v[48:63], a[88:91], a[8:11], v[48:63]
    v_mfma_f32_32x32x16_bf16 v[48:63], a[92:95], a[12:15], v[48:63]
    s_add_u32 m0, s48, 98304
    s_lshl_b32 s50, s94, 7
    s_add_u32 s50, s50, s45
    buffer_load_dwordx4 v6, s[16:19], s50 offen offset:0 lds
    buffer_load_dwordx4 v7, s[16:19], s50 offen offset:1024 lds
    buffer_load_dwordx4 v8, s[16:19], s50 offen offset:2048 lds
    buffer_load_dwordx4 v9, s[16:19], s50 offen offset:3072 lds
    s_waitcnt vmcnt(12)
    ds_read_b128 a[48:51], v32 offset:49152
    ds_read_b128 a[52:55], v33 offset:49152
    ds_read_b128 a[56:59], v34 offset:49152
    ds_read_b128 a[60:63], v35 offset:49152
    s_waitcnt lgkmcnt(8)
    v_mfma_f32_32x32x16_bf16 v[16:31], a[32:35], v[64:67], v[16:31]
    ds_read_b128 v[64:67], v37 offset:256
    v_mfma_f32_32x32x16_bf16 v[16:31], a[36:39], v[68:71], v[16:31]
    ds_read_b128 v[68:71], v37 offset:288
    v_mfma_f32_32x32x16_bf16 v[16:31], a[40:43], v[72:75], v[16:31]
    ds_read_b128 v[72:75], v37 offset:320
    v_mfma_f32_32x32x16_bf16 v[16:31], a[44:47], v[76:79], v[16:31]
    ds_read_b128 v[76:79], v37 offset:352
    s_waitcnt lgkmcnt(8)
    v_mfma_f32_32x32x16_bf16 v[48:63], a[96:99], a[16:19], v[48:63]
    v_mfma_f32_32x32x16_bf16 v[48:63], a[100:103], a[20:23], v[48:63]
    v_mfma_f32_32x32x16_bf16 v[48:63], a[104:107], a[24:27], v[48:63]
    v_mfma_f32_32x32x16_bf16 v[48:63], a[108:111], a[28:31], v[48:63]
    s_mov_b32 s95, 61440
    buffer_load_dword v13, v11, s[36:39], s95 offen sc1
    s_add_u32 m0, s49, 114688
    s_mul_i32 s51, s88, 229376
    s_add_u32 s51, s51, s46
    buffer_load_dwordx4 v40, s[20:23], s51 offen offset:0 lds
    buffer_load_dwordx4 v41, s[20:23], s51 offen offset:1024 lds
    s_add_u32 m0, s49, 122880
    s_mul_i32 s51, s89, 229376
    s_add_u32 s51, s51, s46
    buffer_load_dwordx4 v40, s[20:23], s51 offen offset:0 lds
    buffer_load_dwordx4 v41, s[20:23], s51 offen offset:1024 lds
    s_waitcnt vmcnt(13)
    v_add_u32 v32, 0x10000, v32
    v_add_u32 v33, 0x10000, v33
    v_add_u32 v34, 0x10000, v34
    v_add_u32 v35, 0x10000, v35
    ds_read_b128 a[64:67], v32 offset:0
    ds_read_b128 a[68:71], v33 offset:0
    ds_read_b128 a[72:75], v34 offset:0
    ds_read_b128 a[76:79], v35 offset:0
    s_waitcnt lgkmcnt(8)
    v_mfma_f32_32x32x16_bf16 v[16:31], a[48:51], v[80:83], v[16:31]
    ds_read_b128 v[80:83], v37 offset:384
    v_mfma_f32_32x32x16_bf16 v[16:31], a[52:55], v[84:87], v[16:31]
    ds_read_b128 v[84:87], v37 offset:416
    v_mfma_f32_32x32x16_bf16 v[16:31], a[56:59], v[88:91], v[16:31]
    ds_read_b128 v[88:91], v37 offset:448
    v_mfma_f32_32x32x16_bf16 v[16:31], a[60:63], v[92:95], v[16:31]
    ds_read_b128 v[92:95], v37 offset:480
    s_waitcnt lgkmcnt(8)
    v_mfma_f32_32x32x16_bf16 v[48:63], v[64:67], a[32:35], v[48:63]
    v_mfma_f32_32x32x16_bf16 v[48:63], v[68:71], a[36:39], v[48:63]
    v_mfma_f32_32x32x16_bf16 v[48:63], v[72:75], a[40:43], v[48:63]
    v_mfma_f32_32x32x16_bf16 v[48:63], v[76:79], a[44:47], v[48:63]
    s_add_u32 m0, s49, 131072
    s_mul_i32 s51, s90, 229376
    s_add_u32 s51, s51, s46
    buffer_load_dwordx4 v40, s[20:23], s51 offen offset:0 lds
    buffer_load_dwordx4 v41, s[20:23], s51 offen offset:1024 lds
    s_add_u32 m0, s49, 139264
    s_mul_i32 s51, s91, 229376
    s_add_u32 s51, s51, s46
    buffer_load_dwordx4 v40, s[20:23], s51 offen offset:0 lds
    buffer_load_dwordx4 v41, s[20:23], s51 offen offset:1024 lds
    s_waitcnt vmcnt(13)
    ds_read_b128 a[80:83], v32 offset:16384
    ds_read_b128 a[84:87], v33 offset:16384
    ds_read_b128 a[88:91], v34 offset:16384
    ds_read_b128 a[92:95], v35 offset:16384
    s_waitcnt lgkmcnt(8)
    v_mfma_f32_32x32x16_bf16 v[16:31], a[64:67], v[96:99], v[16:31]
    ds_read_b128 v[96:99], v37 offset:512
    v_mfma_f32_32x32x16_bf16 v[16:31], a[68:71], v[100:103], v[16:31]
    ds_read_b128 v[100:103], v37 offset:544
    v_mfma_f32_32x32x16_bf16 v[16:31], a[72:75], v[104:107], v[16:31]
    ds_read_b128 v[104:107], v37 offset:576
    v_mfma_f32_32x32x16_bf16 v[16:31], a[76:79], v[108:111], v[16:31]
    ds_read_b128 v[108:111], v37 offset:608
    s_waitcnt lgkmcnt(8)
    v_mfma_f32_32x32x16_bf16 v[48:63], v[80:83], a[48:51], v[48:63]
    v_mfma_f32_32x32x16_bf16 v[48:63], v[84:87], a[52:55], v[48:63]
    v_mfma_f32_32x32x16_bf16 v[48:63], v[88:91], a[56:59], v[48:63]
    v_mfma_f32_32x32x16_bf16 v[48:63], v[92:95], a[60:63], v[48:63]
    s_add_u32 m0, s49, 147456
    s_mul_i32 s51, s92, 229376
    s_add_u32 s51, s51, s46
    buffer_load_dwordx4 v40, s[20:23], s51 offen offset:0 lds
    buffer_load_dwordx4 v41, s[20:23], s51 offen offset:1024 lds
    s_waitcnt vmcnt(11)
    ds_read_b128 a[96:99], v32 offset:32768
    ds_read_b128 a[100:103], v33 offset:32768
    ds_read_b128 a[104:107], v34 offset:32768
    ds_read_b128 a[108:111], v35 offset:32768
    s_waitcnt lgkmcnt(8)
    v_mfma_f32_32x32x16_bf16 v[16:31], a[80:83], v[112:115], v[16:31]
    ds_read_b128 v[112:115], v37 offset:640
    v_mfma_f32_32x32x16_bf16 v[16:31], a[84:87], v[116:119], v[16:31]
    ds_read_b128 v[116:119], v37 offset:672
    v_mfma_f32_32x32x16_bf16 v[16:31], a[88:91], v[120:123], v[16:31]
    ds_read_b128 v[120:123], v37 offset:704
    v_mfma_f32_32x32x16_bf16 v[16:31], a[92:95], v[124:127], v[16:31]
    ds_read_b128 v[124:127], v37 offset:736
    s_waitcnt lgkmcnt(8)
    v_mfma_f32_32x32x16_bf16 v[48:63], v[96:99], a[64:67], v[48:63]
    v_mfma_f32_32x32x16_bf16 v[48:63], v[100:103], a[68:71], v[48:63]
    v_mfma_f32_32x32x16_bf16 v[48:63], v[104:107], a[72:75], v[48:63]
    v_mfma_f32_32x32x16_bf16 v[48:63], v[108:111], a[76:79], v[48:63]
    s_waitcnt lgkmcnt(4)
    v_mfma_f32_32x32x16_bf16 v[16:31], a[96:99], v[128:131], v[16:31]
    ds_read_b128 v[128:131], v37 offset:768
    v_mfma_f32_32x32x16_bf16 v[16:31], a[100:103], v[132:135], v[16:31]
    ds_read_b128 v[132:135], v37 offset:800
    v_mfma_f32_32x32x16_bf16 v[16:31], a[104:107], v[136:139], v[16:31]
    ds_read_b128 v[136:139], v37 offset:832
    v_mfma_f32_32x32x16_bf16 v[16:31], a[108:111], v[140:143], v[16:31]
    ds_read_b128 v[140:143], v37 offset:864
    s_nop 10
    v_permlane16_swap_b32 v16, v20
    v_permlane16_swap_b32 v17, v21
    v_permlane16_swap_b32 v18, v22
    v_permlane16_swap_b32 v19, v23
    v_cvt_pk_bf16_f32 v64, v16, v20
    v_cvt_pk_bf16_f32 v65, v17, v21
    v_cvt_pk_bf16_f32 v66, v18, v22
    v_cvt_pk_bf16_f32 v67, v19, v23
    buffer_store_dwordx4 v[64:67], v36, s[32:35], s55 offen offset:0 sc1
    v_permlane16_swap_b32 v24, v28
    v_permlane16_swap_b32 v25, v29
    v_permlane16_swap_b32 v26, v30
    v_permlane16_swap_b32 v27, v31
    v_cvt_pk_bf16_f32 v68, v24, v28
    v_cvt_pk_bf16_f32 v69, v25, v29
    v_cvt_pk_bf16_f32 v70, v26, v30
    v_cvt_pk_bf16_f32 v71, v27, v31
    buffer_store_dwordx4 v[68:71], v36, s[32:35], s55 offen offset:64 sc1
    s_waitcnt lgkmcnt(0)
    v_mfma_f32_32x32x16_bf16 v[48:63], v[112:115], a[80:83], v[48:63]
    v_mfma_f32_32x32x16_bf16 v[48:63], v[116:119], a[84:87], v[48:63]
    v_mfma_f32_32x32x16_bf16 v[48:63], v[120:123], a[88:91], v[48:63]
    v_mfma_f32_32x32x16_bf16 v[48:63], v[124:127], a[92:95], v[48:63]
    v_mfma_f32_32x32x16_bf16 v[48:63], v[128:131], a[96:99], v[48:63]
    v_mfma_f32_32x32x16_bf16 v[48:63], v[132:135], a[100:103], v[48:63]
    v_mfma_f32_32x32x16_bf16 v[48:63], v[136:139], a[104:107], v[48:63]
    v_mfma_f32_32x32x16_bf16 v[48:63], v[140:143], a[108:111], v[48:63]
    s_waitcnt vmcnt(8)
    s_barrier
    s_add_u32 m0, s49, 155648
    s_mul_i32 s51, s93, 229376
    s_add_u32 s51, s51, s46
    buffer_load_dwordx4 v40, s[20:23], s51 offen offset:0 lds
    buffer_load_dwordx4 v41, s[20:23], s51 offen offset:1024 lds
    s_nop 4
    v_mul_f32 v48, 0x3fb8aa3b, v48
    v_exp_f32 v103, v48
    v_exp_f32 v49, -v48
    v_add_f32 v103, 1.0, v103
    v_min_f32 v103, 0x7f000000, v103
    v_add_f32 v49, 1.0, v49
    v_rcp_f32 v49, v49
    s_nop 0
    v_mul_f32 v49, 0x36124925, v49
    v_cmp_eq_u32 vcc, 0, v14
    v_lshlrev_b32 v50, 2, v12
    v_lshl_add_u32 v50, v14, 13, v50
    v_cndmask_b32 v49, v49, v103, vcc
    s_lshl_b32 s59, s53, 7
    s_lshl_b32 s95, s44, 14
    s_add_u32 s59, s59, s95
    buffer_store_dword v49, v50, s[76:79], s59 offen sc1
    s_mov_b32 s24, s10
    s_mov_b32 s25, s11
    s_mov_b32 s26, 3584
    s_mov_b32 s27, 0x20000
    v_lshlrev_b32 v3, 1, v12
    buffer_load_ushort v104, v3, s[24:27], s47 offen offset:128
    buffer_load_ushort v108, v3, s[24:27], s47 offen offset:192
    v_bfe_u32 v16, v1, 2, 2
    v_lshl_add_u32 v3, v14, 3, v16
    v_lshlrev_b32 v3, 7, v3
    v_lshrrev_b32 v4, 1, v16
    v_lshlrev_b32 v4, 6, v4
    v_bfe_u32 v16, v1, 4, 1
    v_lshlrev_b32 v16, 5, v16
    v_add3_u32 v100, v3, v4, v16
    v_and_b32 v16, 3, v1
    v_lshl_add_u32 v100, v16, 3, v100
    v_xor_b32 v101, 64, v100
    v_mov_b32 v105, 0
    v_mov_b32 v106, 0
    v_mov_b32 v107, 0
    v_mov_b32 v109, 0
    v_mov_b32 v110, 0
    v_mov_b32 v111, 0
    v_mov_b32 v113, 0
    v_mov_b32 v114, 0
    v_mov_b32 v115, 0
    v_cmp_eq_u32 vcc, 0, v14
    v_mov_b32 v3, 0x3f80
    s_nop 0
    v_cndmask_b32 v112, 0, v3, vcc
    v_mov_b32 v116, 0xc0135761
    v_mov_b32 v117, 0xc0135761
    v_mov_b32 v118, 0xbdd2d3e8
    v_mov_b32 v119, 0xbdd2d3e8
    s_lshl_b32 s53, s43, 2
    s_add_u32 s53, s53, s40
    s_mul_i32 s58, s53, 114688
    s_lshl_b32 s55, s44, 13
    s_add_u32 s58, s58, s55
    s_add_u32 s58, s58, 4096
    s_waitcnt vmcnt(9)
    v_readfirstlane_b32 s14, v13
    s_waitcnt lgkmcnt(0)
    s_mul_i32 s14, s14, 0x9e3779b1
    s_add_u32 s14, s14, 0x7f4a7c15
    v_mov_b32 v13, s14
    s_barrier
    s_add_u32 m0, s49, 114688
    s_mul_i32 s51, s94, 229376
    s_add_u32 s51, s51, s46
    buffer_load_dwordx4 v40, s[20:23], s51 offen offset:0 lds
    buffer_load_dwordx4 v41, s[20:23], s51 offen offset:1024 lds
    s_add_u32 m0, s49, 0
    s_mul_i32 s51, s88, 229376
    s_add_u32 s51, s51, s46
    s_add_u32 s51, s51, 128
    buffer_load_dwordx4 v40, s[20:23], s51 offen offset:0 lds
    buffer_load_dwordx4 v41, s[20:23], s51 offen offset:1024 lds
    s_add_u32 m0, s49, 8192
    s_mul_i32 s51, s89, 229376
    s_add_u32 s51, s51, s46
    s_add_u32 s51, s51, 128
    buffer_load_dwordx4 v40, s[20:23], s51 offen offset:0 lds
    buffer_load_dwordx4 v41, s[20:23], s51 offen offset:1024 lds
    s_add_u32 m0, s49, 16384
    s_mul_i32 s51, s90, 229376
    s_add_u32 s51, s51, s46
    s_add_u32 s51, s51, 128
    buffer_load_dwordx4 v40, s[20:23], s51 offen offset:0 lds
    buffer_load_dwordx4 v41, s[20:23], s51 offen offset:1024 lds
    s_add_u32 m0, s49, 24576
    s_mul_i32 s51, s91, 229376
    s_add_u32 s51, s51, s46
    s_add_u32 s51, s51, 128
    buffer_load_dwordx4 v40, s[20:23], s51 offen offset:0 lds
    buffer_load_dwordx4 v41, s[20:23], s51 offen offset:1024 lds
    v_and_b32 v6, 7, v1
    v_bfe_u32 v3, v1, 4, 1
    v_lshlrev_b32 v3, 2, v3
    v_xor_b32 v6, v6, v3
    v_lshlrev_b32 v6, 4, v6
    v_lshrrev_b32 v3, 3, v1
    v_mul_u32_u24 v3, 896, v3
    v_add_u32 v6, v6, v3
    v_add_u32 v7, 6144, v6
    v_add_u32 v8, 12288, v6
    v_add_u32 v9, 18432, v6
    s_waitcnt vmcnt(12)
    s_barrier
    s_cmp_eq_u32 s40, 0
    s_cbranch_scc0 K_NOY
    s_lshl_b32 s96, s44, 11
    s_lshl_b32 s95, s43, 7
    s_add_u32 s96, s96, s95
    s_add_u32 s96, s96, 524288
    s_mov_b64 exec, 1
    buffer_store_dword v13, v11, s[36:39], s96 offen sc1
    s_mov_b64 exec, -1
K_NOY:
    s_add_u32 m0, s49, 32768
    s_mul_i32 s51, s92, 229376
    s_add_u32 s51, s51, s46
    s_add_u32 s51, s51, 128
    buffer_load_dwordx4 v40, s[20:23], s51 offen offset:0 lds
    buffer_load_dwordx4 v41, s[20:23], s51 offen offset:1024 lds
    s_add_u32 m0, s49, 40960
    s_mul_i32 s51, s93, 229376
    s_add_u32 s51, s51, s46
    s_add_u32 s51, s51, 128
    buffer_load_dwordx4 v40, s[20:23], s51 offen offset:0 lds
    buffer_load_dwordx4 v41, s[20:23], s51 offen offset:1024 lds
    s_add_u32 m0, s49, 49152
    s_mul_i32 s51, s94, 229376
    s_add_u32 s51, s51, s46
    s_add_u32 s51, s51, 128
    buffer_load_dwordx4 v40, s[20:23], s51 offen offset:0 lds
    buffer_load_dwordx4 v41, s[20:23], s51 offen offset:1024 lds
    s_and_b32 s95, s41, 1
    s_mul_i32 s95, s95, 56
    s_mul_i32 s88, s40, 14
    s_add_u32 s88, s88, s95
    s_add_u32 s89, s88, 2
    s_add_u32 s90, s88, 4
    s_add_u32 s91, s88, 6
    s_add_u32 s92, s88, 8
    s_add_u32 s93, s88, 10
    s_add_u32 s94, s88, 12
    s_lshl_b32 s47, s15, 7
    s_waitcnt vmcnt(14)
    s_barrier
    s_add_u32 m0, s48, 131072
    s_mul_i32 s50, s88, 14336
    s_add_u32 s50, s50, s47
    buffer_load_dwordx4 v6, s[64:67], s50 offen offset:0 lds
    buffer_load_dwordx4 v7, s[64:67], s50 offen offset:1024 lds
    buffer_load_dwordx4 v8, s[64:67], s50 offen offset:2048 lds
    buffer_load_dwordx4 v9, s[64:67], s50 offen offset:3072 lds
    v_mfma_f32_32x32x16_bf16 v[16:31], v[104:107], v[112:115], 0
    v_mfma_f32_32x32x16_bf16 v[32:47], v[108:111], v[112:115], 0
    s_waitcnt vmcnt(10)
    s_waitcnt lgkmcnt(0)
    s_barrier
    s_setprio 1
    ds_read_b64_tr_b16 v[64:65], v100 offset:0
    ds_read_b64_tr_b16 v[66:67], v100 offset:512
    ds_read_b64_tr_b16 v[68:69], v101 offset:0
    ds_read_b64_tr_b16 v[70:71], v101 offset:512
    ds_read_b64_tr_b16 v[72:73], v100 offset:2048
    ds_read_b64_tr_b16 v[74:75], v100 offset:2560
    ds_read_b64_tr_b16 v[76:77], v101 offset:2048
    ds_read_b64_tr_b16 v[78:79], v101 offset:2560
    ds_read_b64_tr_b16 v[80:81], v100 offset:4096
    ds_read_b64_tr_b16 v[82:83], v100 offset:4608
    ds_read_b64_tr_b16 v[84:85], v101 offset:4096
    ds_read_b64_tr_b16 v[86:87], v101 offset:4608
    s_waitcnt lgkmcnt(8)
    v_mfma_f32_32x32x16_bf16 v[16:31], v[64:67], a[0:3], v[16:31]
    ds_read_b64_tr_b16 v[88:89], v100 offset:6144
    ds_read_b64_tr_b16 v[90:91], v100 offset:6656
    ds_read_b64_tr_b16 v[92:93], v101 offset:6144
    ds_read_b64_tr_b16 v[94:95], v101 offset:6656
    v_mfma_f32_32x32x16_bf16 v[32:47], v[68:71], a[0:3], v[32:47]
    s_waitcnt lgkmcnt(8)
    v_mfma_f32_32x32x16_bf16 v[16:31], v[72:75], a[4:7], v[16:31]
    ds_read_b64_tr_b16 v[64:65], v100 offset:8192
    ds_read_b64_tr_b16 v[66:67], v100 offset:8704
    ds_read_b64_tr_b16 v[68:69], v101 offset:8192
    ds_read_b64_tr_b16 v[70:71], v101 offset:8704
    v_mfma_f32_32x32x16_bf16 v[32:47], v[76:79], a[4:7], v[32:47]
    s_waitcnt lgkmcnt(8)
    v_mfma_f32_32x32x16_bf16 v[16:31], v[80:83], a[8:11], v[16:31]
    ds_read_b64_tr_b16 v[72:73], v100 offset:10240
    ds_read_b64_tr_b16 v[74:75], v100 offset:10752
    ds_read_b64_tr_b16 v[76:77], v101 offset:10240
    ds_read_b64_tr_b16 v[78:79], v101 offset:10752
    v_mfma_f32_32x32x16_bf16 v[32:47], v[84:87], a[8:11], v[32:47]
    s_waitcnt lgkmcnt(8)
    v_mfma_f32_32x32x16_bf16 v[16:31], v[88:91], a[12:15], v[16:31]
    ds_read_b64_tr_b16 v[80:81], v100 offset:12288
    ds_read_b64_tr_b16 v[82:83], v100 offset:12800
    ds_read_b64_tr_b16 v[84:85], v101 offset:12288
    ds_read_b64_tr_b16 v[86:87], v101 offset:12800
    v_mfma_f32_32x32x16_bf16 v[32:47], v[92:95], a[12:15], v[32:47]
    s_waitcnt lgkmcnt(8)
    v_mfma_f32_32x32x16_bf16 v[16:31], v[64:67], a[16:19], v[16:31]
    ds_read_b64_tr_b16 v[88:89], v100 offset:14336
    ds_read_b64_tr_b16 v[90:91], v100 offset:14848
    ds_read_b64_tr_b16 v[92:93], v101 offset:14336
    ds_read_b64_tr_b16 v[94:95], v101 offset:14848
    v_mfma_f32_32x32x16_bf16 v[32:47], v[68:71], a[16:19], v[32:47]
    s_waitcnt lgkmcnt(8)
    v_mfma_f32_32x32x16_bf16 v[16:31], v[72:75], a[20:23], v[16:31]
    ds_read_b64_tr_b16 v[64:65], v100 offset:16384
    ds_read_b64_tr_b16 v[66:67], v100 offset:16896
    ds_read_b64_tr_b16 v[68:69], v101 offset:16384
    ds_read_b64_tr_b16 v[70:71], v101 offset:16896
    v_mfma_f32_32x32x16_bf16 v[32:47], v[76:79], a[20:23], v[32:47]
    s_waitcnt lgkmcnt(8)
    v_mfma_f32_32x32x16_bf16 v[16:31], v[80:83], a[24:27], v[16:31]
    ds_read_b64_tr_b16 v[72:73], v100 offset:18432
    ds_read_b64_tr_b16 v[74:75], v100 offset:18944
    ds_read_b64_tr_b16 v[76:77], v101 offset:18432
    ds_read_b64_tr_b16 v[78:79], v101 offset:18944
    v_mfma_f32_32x32x16_bf16 v[32:47], v[84:87], a[24:27], v[32:47]
    s_waitcnt lgkmcnt(8)
    v_mfma_f32_32x32x16_bf16 v[16:31], v[88:91], a[28:31], v[16:31]
    ds_read_b64_tr_b16 v[80:81], v100 offset:20480
    ds_read_b64_tr_b16 v[82:83], v100 offset:20992
    ds_read_b64_tr_b16 v[84:85], v101 offset:20480
    ds_read_b64_tr_b16 v[86:87], v101 offset:20992
    v_mfma_f32_32x32x16_bf16 v[32:47], v[92:95], a[28:31], v[32:47]
    s_waitcnt vmcnt(4)
    s_barrier
    s_waitcnt lgkmcnt(8)
    v_mfma_f32_32x32x16_bf16 v[16:31], v[64:67], a[32:35], v[16:31]
    ds_read_b64_tr_b16 v[88:89], v100 offset:22528
    ds_read_b64_tr_b16 v[90:91], v100 offset:23040
    ds_read_b64_tr_b16 v[92:93], v101 offset:22528
    ds_read_b64_tr_b16 v[94:95], v101 offset:23040
    v_mfma_f32_32x32x16_bf16 v[32:47], v[68:71], a[32:35], v[32:47]
    s_waitcnt lgkmcnt(8)
    v_mfma_f32_32x32x16_bf16 v[16:31], v[72:75], a[36:39], v[16:31]
    ds_read_b64_tr_b16 v[64:65], v100 offset:24576
    ds_read_b64_tr_b16 v[66:67], v100 offset:25088
    ds_read_b64_tr_b16 v[68:69], v101 offset:24576
    ds_read_b64_tr_b16 v[70:71], v101 offset:25088
    v_mfma_f32_32x32x16_bf16 v[32:47], v[76:79], a[36:39], v[32:47]
    s_waitcnt lgkmcnt(8)
    v_mfma_f32_32x32x16_bf16 v[16:31], v[80:83], a[40:43], v[16:31]
    ds_read_b64_tr_b16 v[72:73], v100 offset:26624
    ds_read_b64_tr_b16 v[74:75], v100 offset:27136
    ds_read_b64_tr_b16 v[76:77], v101 offset:26624
    ds_read_b64_tr_b16 v[78:79], v101 offset:27136
    v_mfma_f32_32x32x16_bf16 v[32:47], v[84:87], a[40:43], v[32:47]
    s_waitcnt lgkmcnt(8)
    v_mfma_f32_32x32x16_bf16 v[16:31], v[88:91], a[44:47], v[16:31]
    ds_read_b64_tr_b16 v[80:81], v100 offset:28672
    ds_read_b64_tr_b16 v[82:83], v100 offset:29184
    ds_read_b64_tr_b16 v[84:85], v101 offset:28672
    ds_read_b64_tr_b16 v[86:87], v101 offset:29184
    v_mfma_f32_32x32x16_bf16 v[32:47], v[92:95], a[44:47], v[32:47]
    s_waitcnt lgkmcnt(8)
    v_mfma_f32_32x32x16_bf16 v[16:31], v[64:67], a[48:51], v[16:31]
    ds_read_b64_tr_b16 v[88:89], v100 offset:30720
    ds_read_b64_tr_b16 v[90:91], v100 offset:31232
    ds_read_b64_tr_b16 v[92:93], v101 offset:30720
    ds_read_b64_tr_b16 v[94:95], v101 offset:31232
    v_mfma_f32_32x32x16_bf16 v[32:47], v[68:71], a[48:51], v[32:47]
    s_waitcnt lgkmcnt(8)
    v_mfma_f32_32x32x16_bf16 v[16:31], v[72:75], a[52:55], v[16:31]
    ds_read_b64_tr_b16 v[64:65], v100 offset:32768
    ds_read_b64_tr_b16 v[66:67], v100 offset:33280
    ds_read_b64_tr_b16 v[68:69], v101 offset:32768
    ds_read_b64_tr_b16 v[70:71], v101 offset:33280
    v_mfma_f32_32x32x16_bf16 v[32:47], v[76:79], a[52:55], v[32:47]
    s_waitcnt lgkmcnt(8)
    v_mfma_f32_32x32x16_bf16 v[16:31], v[80:83], a[56:59], v[16:31]
    ds_read_b64_tr_b16 v[72:73], v100 offset:34816
    ds_read_b64_tr_b16 v[74:75], v100 offset:35328
    ds_read_b64_tr_b16 v[76:77], v101 offset:34816
    ds_read_b64_tr_b16 v[78:79], v101 offset:35328
    v_mfma_f32_32x32x16_bf16 v[32:47], v[84:87], a[56:59], v[32:47]
    s_waitcnt lgkmcnt(8)
    v_mfma_f32_32x32x16_bf16 v[16:31], v[88:91], a[60:63], v[16:31]
    ds_read_b64_tr_b16 v[80:81], v100 offset:36864
    ds_read_b64_tr_b16 v[82:83], v100 offset:37376
    ds_read_b64_tr_b16 v[84:85], v101 offset:36864
    ds_read_b64_tr_b16 v[86:87], v101 offset:37376
    v_mfma_f32_32x32x16_bf16 v[32:47], v[92:95], a[60:63], v[32:47]
    s_waitcnt lgkmcnt(8)
    v_mfma_f32_32x32x16_bf16 v[16:31], v[64:67], a[64:67], v[16:31]
    ds_read_b64_tr_b16 v[88:89], v100 offset:38912
    ds_read_b64_tr_b16 v[90:91], v100 offset:39424
    ds_read_b64_tr_b16 v[92:93], v101 offset:38912
    ds_read_b64_tr_b16 v[94:95], v101 offset:39424
    v_mfma_f32_32x32x16_bf16 v[32:47], v[68:71], a[64:67], v[32:47]
    s_waitcnt lgkmcnt(8)
    v_mfma_f32_32x32x16_bf16 v[16:31], v[72:75], a[68:71], v[16:31]
    ds_read_b64_tr_b16 v[64:65], v100 offset:40960
    ds_read_b64_tr_b16 v[66:67], v100 offset:41472
    ds_read_b64_tr_b16 v[68:69], v101 offset:40960
    ds_read_b64_tr_b16 v[70:71], v101 offset:41472
    v_mfma_f32_32x32x16_bf16 v[32:47], v[76:79], a[68:71], v[32:47]
    s_waitcnt lgkmcnt(8)
    v_mfma_f32_32x32x16_bf16 v[16:31], v[80:83], a[72:75], v[16:31]
    ds_read_b64_tr_b16 v[72:73], v100 offset:43008
    ds_read_b64_tr_b16 v[74:75], v100 offset:43520
    ds_read_b64_tr_b16 v[76:77], v101 offset:43008
    ds_read_b64_tr_b16 v[78:79], v101 offset:43520
    v_mfma_f32_32x32x16_bf16 v[32:47], v[84:87], a[72:75], v[32:47]
    s_waitcnt lgkmcnt(8)
    v_mfma_f32_32x32x16_bf16 v[16:31], v[88:91], a[76:79], v[16:31]
    ds_read_b64_tr_b16 v[80:81], v100 offset:45056
    ds_read_b64_tr_b16 v[82:83], v100 offset:45568
    ds_read_b64_tr_b16 v[84:85], v101 offset:45056
    ds_read_b64_tr_b16 v[86:87], v101 offset:45568
    v_mfma_f32_32x32x16_bf16 v[32:47], v[92:95], a[76:79], v[32:47]
    s_waitcnt lgkmcnt(8)
    v_mfma_f32_32x32x16_bf16 v[16:31], v[64:67], a[80:83], v[16:31]
    ds_read_b64_tr_b16 v[88:89], v100 offset:47104
    ds_read_b64_tr_b16 v[90:91], v100 offset:47616
    ds_read_b64_tr_b16 v[92:93], v101 offset:47104
    ds_read_b64_tr_b16 v[94:95], v101 offset:47616
    v_mfma_f32_32x32x16_bf16 v[32:47], v[68:71], a[80:83], v[32:47]
    s_waitcnt lgkmcnt(8)
    v_mfma_f32_32x32x16_bf16 v[16:31], v[72:75], a[84:87], v[16:31]
    ds_read_b64_tr_b16 v[64:65], v100 offset:49152
    ds_read_b64_tr_b16 v[66:67], v100 offset:49664
    ds_read_b64_tr_b16 v[68:69], v101 offset:49152
    ds_read_b64_tr_b16 v[70:71], v101 offset:49664
    v_mfma_f32_32x32x16_bf16 v[32:47], v[76:79], a[84:87], v[32:47]
    s_waitcnt lgkmcnt(8)
    v_mfma_f32_32x32x16_bf16 v[16:31], v[80:83], a[88:91], v[16:31]
    ds_read_b64_tr_b16 v[72:73], v100 offset:51200
    ds_read_b64_tr_b16 v[74:75], v100 offset:51712
    ds_read_b64_tr_b16 v[76:77], v101 offset:51200
    ds_read_b64_tr_b16 v[78:79], v101 offset:51712
    v_mfma_f32_32x32x16_bf16 v[32:47], v[84:87], a[88:91], v[32:47]
    s_waitcnt lgkmcnt(8)
    v_mfma_f32_32x32x16_bf16 v[16:31], v[88:91], a[92:95], v[16:31]
    ds_read_b64_tr_b16 v[80:81], v100 offset:53248
    ds_read_b64_tr_b16 v[82:83], v100 offset:53760
    ds_read_b64_tr_b16 v[84:85], v101 offset:53248
    ds_read_b64_tr_b16 v[86:87], v101 offset:53760
    v_mfma_f32_32x32x16_bf16 v[32:47], v[92:95], a[92:95], v[32:47]
    s_waitcnt lgkmcnt(8)
    v_mfma_f32_32x32x16_bf16 v[16:31], v[64:67], a[96:99], v[16:31]
    ds_read_b64_tr_b16 v[88:89], v100 offset:55296
    ds_read_b64_tr_b16 v[90:91], v100 offset:55808
    ds_read_b64_tr_b16 v[92:93], v101 offset:55296
    ds_read_b64_tr_b16 v[94:95], v101 offset:55808
    v_mfma_f32_32x32x16_bf16 v[32:47], v[68:71], a[96:99], v[32:47]
    s_waitcnt lgkmcnt(8)
    v_mfma_f32_32x32x16_bf16 v[16:31], v[72:75], a[100:103], v[16:31]
    v_mfma_f32_32x32x16_bf16 v[32:47], v[76:79], a[100:103], v[32:47]
    s_waitcnt lgkmcnt(4)
    v_mfma_f32_32x32x16_bf16 v[16:31], v[80:83], a[104:107], v[16:31]
    v_mfma_f32_32x32x16_bf16 v[32:47], v[84:87], a[104:107], v[32:47]
    s_waitcnt lgkmcnt(0)
    v_mfma_f32_32x32x16_bf16 v[16:31], v[88:91], a[108:111], v[16:31]
    v_mfma_f32_32x32x16_bf16 v[32:47], v[92:95], a[108:111], v[32:47]
    s_setprio 0
    s_setprio 2
    v_mov_b32 v114, v103
    v_mov_b32 v115, v103
    s_mov_b32 s45, s53
    s_mov_b32 s52, s44
    s_lshr_b32 s43, s41, 1
    s_lshl_b32 s43, s43, 2
    s_add_u32 s43, s43, s3
    s_lshl_b32 s43, s43, 1
    s_and_b32 s95, s41, 1
    s_add_u32 s43, s43, s95
    s_lshr_b32 s95, s40, 1
    s_and_b32 s44, s40, 1
    s_lshl_b32 s53, s43, 1
    s_add_u32 s53, s53, s95
    s_xor_b32 s55, s53, 1
    s_mul_i32 s56, s53, 114688
    s_mul_i32 s57, s55, 114688
    v_and_b32 v2, 3, v1
    v_bfe_u32 v3, v1, 2, 1
    v_lshl_add_u32 v2, v3, 5, v2
    v_lshlrev_b32 v2, 7, v2
    s_lshl_b32 s59, s43, 13
    s_lshr_b32 s95, s88, 2
    s_lshl_b32 s95, s95, 7
    s_add_u32 s59, s59, s95
    s_add_u32 s59, s59, 65536
    s_mov_b32 s98, s59
    v_pk_mul_f32 v[104:105], v[16:17], v[16:17]
    v_pk_mul_f32 v[106:107], v[18:19], v[18:19]
    v_pk_fma_f32 v[104:105], v[104:105], v[118:119], v[116:117]
    v_pk_fma_f32 v[106:107], v[106:107], v[118:119], v[116:117]
    v_pk_mul_f32 v[104:105], v[16:17], v[104:105]
    v_pk_mul_f32 v[106:107], v[18:19], v[106:107]
    v_exp_f32 v104, v104
    v_exp_f32 v106, v106
    v_exp_f32 v105, v105
    v_exp_f32 v107, v107
    v_pk_fma_f32 v[104:105], v[104:105], v[114:115], v[114:115]
    v_pk_fma_f32 v[106:107], v[106:107], v[114:115], v[114:115]
    v_rcp_f32 v104, v104
    v_rcp_f32 v106, v106
    v_rcp_f32 v105, v105
    v_rcp_f32 v107, v107
    v_pk_mul_f32 v[104:105], v[16:17], v[104:105]
    v_pk_mul_f32 v[106:107], v[18:19], v[106:107]
    v_cvt_pk_bf16_f32 v64, v104, v105
    v_cvt_pk_bf16_f32 v65, v106, v107
    v_pk_mul_f32 v[104:105], v[20:21], v[20:21]
    v_pk_mul_f32 v[106:107], v[22:23], v[22:23]
    v_pk_fma_f32 v[104:105], v[104:105], v[118:119], v[116:117]
    v_pk_fma_f32 v[106:107], v[106:107], v[118:119], v[116:117]
    v_pk_mul_f32 v[104:105], v[20:21], v[104:105]
    v_pk_mul_f32 v[106:107], v[22:23], v[106:107]
    v_exp_f32 v104, v104
    v_exp_f32 v106, v106
    v_exp_f32 v105, v105
    v_exp_f32 v107, v107
    v_pk_fma_f32 v[104:105], v[104:105], v[114:115], v[114:115]
    v_pk_fma_f32 v[106:107], v[106:107], v[114:115], v[114:115]
    v_rcp_f32 v104, v104
    v_rcp_f32 v106, v106
    v_rcp_f32 v105, v105
    v_rcp_f32 v107, v107
    v_pk_mul_f32 v[104:105], v[20:21], v[104:105]
    v_pk_mul_f32 v[106:107], v[22:23], v[106:107]
    v_cvt_pk_bf16_f32 v66, v104, v105
    v_cvt_pk_bf16_f32 v67, v106, v107
    buffer_store_dwordx4 v[64:67], v10, s[28:31], s58 offen offset:0 sc1
    v_pk_mul_f32 v[104:105], v[24:25], v[24:25]
    v_pk_mul_f32 v[106:107], v[26:27], v[26:27]
    v_pk_fma_f32 v[104:105], v[104:105], v[118:119], v[116:117]
    v_pk_fma_f32 v[106:107], v[106:107], v[118:119], v[116:117]
    v_pk_mul_f32 v[104:105], v[24:25], v[104:105]
    v_pk_mul_f32 v[106:107], v[26:27], v[106:107]
    v_exp_f32 v104, v104
    v_exp_f32 v106, v106
    v_exp_f32 v105, v105
    v_exp_f32 v107, v107
    v_pk_fma_f32 v[104:105], v[104:105], v[114:115], v[114:115]
    v_pk_fma_f32 v[106:107], v[106:107], v[114:115], v[114:115]
    v_rcp_f32 v104, v104
    v_rcp_f32 v106, v106
    v_rcp_f32 v105, v105
    v_rcp_f32 v107, v107
    v_pk_mul_f32 v[104:105], v[24:25], v[104:105]
    v_pk_mul_f32 v[106:107], v[26:27], v[106:107]
    v_cvt_pk_bf16_f32 v68, v104, v105
    v_cvt_pk_bf16_f32 v69, v106, v107
    v_pk_mul_f32 v[104:105], v[28:29], v[28:29]
    v_pk_mul_f32 v[106:107], v[30:31], v[30:31]
    v_pk_fma_f32 v[104:105], v[104:105], v[118:119], v[116:117]
    v_pk_fma_f32 v[106:107], v[106:107], v[118:119], v[116:117]
    v_pk_mul_f32 v[104:105], v[28:29], v[104:105]
    v_pk_mul_f32 v[106:107], v[30:31], v[106:107]
    v_exp_f32 v104, v104
    v_exp_f32 v106, v106
    v_exp_f32 v105, v105
    v_exp_f32 v107, v107
    v_pk_fma_f32 v[104:105], v[104:105], v[114:115], v[114:115]
    v_pk_fma_f32 v[106:107], v[106:107], v[114:115], v[114:115]
    v_rcp_f32 v104, v104
    v_rcp_f32 v106, v106
    v_rcp_f32 v105, v105
    v_rcp_f32 v107, v107
    v_pk_mul_f32 v[104:105], v[28:29], v[104:105]
    v_pk_mul_f32 v[106:107], v[30:31], v[106:107]
    v_cvt_pk_bf16_f32 v70, v104, v105
    v_cvt_pk_bf16_f32 v71, v106, v107
    buffer_store_dwordx4 v[68:71], v10, s[28:31], s58 offen offset:1024 sc1
    v_pk_mul_f32 v[104:105], v[32:33], v[32:33]
    v_pk_mul_f32 v[106:107], v[34:35], v[34:35]
    v_pk_fma_f32 v[104:105], v[104:105], v[118:119], v[116:117]
    v_pk_fma_f32 v[106:107], v[106:107], v[118:119], v[116:117]
    v_pk_mul_f32 v[104:105], v[32:33], v[104:105]
    v_pk_mul_f32 v[106:107], v[34:35], v[106:107]
    v_exp_f32 v104, v104
    v_exp_f32 v106, v106
    v_exp_f32 v105, v105
    v_exp_f32 v107, v107
    v_pk_fma_f32 v[104:105], v[104:105], v[114:115], v[114:115]
    v_pk_fma_f32 v[106:107], v[106:107], v[114:115], v[114:115]
    v_rcp_f32 v104, v104
    v_rcp_f32 v106, v106
    v_rcp_f32 v105, v105
    v_rcp_f32 v107, v107
    v_pk_mul_f32 v[104:105], v[32:33], v[104:105]
    v_pk_mul_f32 v[106:107], v[34:35], v[106:107]
    v_cvt_pk_bf16_f32 v72, v104, v105
    v_cvt_pk_bf16_f32 v73, v106, v107
    v_pk_mul_f32 v[104:105], v[36:37], v[36:37]
    v_pk_mul_f32 v[106:107], v[38:39], v[38:39]
    v_pk_fma_f32 v[104:105], v[104:105], v[118:119], v[116:117]
    v_pk_fma_f32 v[106:107], v[106:107], v[118:119], v[116:117]
    v_pk_mul_f32 v[104:105], v[36:37], v[104:105]
    v_pk_mul_f32 v[106:107], v[38:39], v[106:107]
    v_exp_f32 v104, v104
    v_exp_f32 v106, v106
    v_exp_f32 v105, v105
    v_exp_f32 v107, v107
    v_pk_fma_f32 v[104:105], v[104:105], v[114:115], v[114:115]
    v_pk_fma_f32 v[106:107], v[106:107], v[114:115], v[114:115]
    v_rcp_f32 v104, v104
    v_rcp_f32 v106, v106
    v_rcp_f32 v105, v105
    v_rcp_f32 v107, v107
    v_pk_mul_f32 v[104:105], v[36:37], v[104:105]
    v_pk_mul_f32 v[106:107], v[38:39], v[106:107]
    v_cvt_pk_bf16_f32 v74, v104, v105
    v_cvt_pk_bf16_f32 v75, v106, v107
    buffer_store_dwordx4 v[72:75], v10, s[28:31], s58 offen offset:2048 sc1
    v_pk_mul_f32 v[104:105], v[40:41], v[40:41]
    v_pk_mul_f32 v[106:107], v[42:43], v[42:43]
    v_pk_fma_f32 v[104:105], v[104:105], v[118:119], v[116:117]
    v_pk_fma_f32 v[106:107], v[106:107], v[118:119], v[116:117]
    v_pk_mul_f32 v[104:105], v[40:41], v[104:105]
    v_pk_mul_f32 v[106:107], v[42:43], v[106:107]
    v_exp_f32 v104, v104
    v_exp_f32 v106, v106
    v_exp_f32 v105, v105
    v_exp_f32 v107, v107
    v_pk_fma_f32 v[104:105], v[104:105], v[114:115], v[114:115]
    v_pk_fma_f32 v[106:107], v[106:107], v[114:115], v[114:115]
    v_rcp_f32 v104, v104
    v_rcp_f32 v106, v106
    v_rcp_f32 v105, v105
    v_rcp_f32 v107, v107
    v_pk_mul_f32 v[104:105], v[40:41], v[104:105]
    v_pk_mul_f32 v[106:107], v[42:43], v[106:107]
    v_cvt_pk_bf16_f32 v76, v104, v105
    v_cvt_pk_bf16_f32 v77, v106, v107
    v_pk_mul_f32 v[104:105], v[44:45], v[44:45]
    v_pk_mul_f32 v[106:107], v[46:47], v[46:47]
    v_pk_fma_f32 v[104:105], v[104:105], v[118:119], v[116:117]
    v_pk_fma_f32 v[106:107], v[106:107], v[118:119], v[116:117]
    v_pk_mul_f32 v[104:105], v[44:45], v[104:105]
    v_pk_mul_f32 v[106:107], v[46:47], v[106:107]
    v_exp_f32 v104, v104
    v_exp_f32 v106, v106
    v_exp_f32 v105, v105
    v_exp_f32 v107, v107
    v_pk_fma_f32 v[104:105], v[104:105], v[114:115], v[114:115]
    v_pk_fma_f32 v[106:107], v[106:107], v[114:115], v[114:115]
    v_rcp_f32 v104, v104
    v_rcp_f32 v106, v106
    v_rcp_f32 v105, v105
    v_rcp_f32 v107, v107
    v_pk_mul_f32 v[104:105], v[44:45], v[104:105]
    v_pk_mul_f32 v[106:107], v[46:47], v[106:107]
    v_cvt_pk_bf16_f32 v78, v104, v105
    v_cvt_pk_bf16_f32 v79, v106, v107
    buffer_store_dwordx4 v[76:79], v10, s[28:31], s58 offen offset:3072 sc1
    v_bfe_u32 v139, v1, 2, 2
    v_lshl_add_u32 v3, v14, 2, v139
    v_lshlrev_b32 v3, 7, v3
    v_lshrrev_b32 v4, 1, v139
    v_xor_b32 v4, s44, v4
    v_lshlrev_b32 v4, 6, v4
    v_bfe_u32 v139, v1, 4, 1
    v_lshlrev_b32 v139, 5, v139
    v_add3_u32 v138, v3, v4, v139
    v_and_b32 v139, 3, v1
    v_lshl_add_u32 v138, v139, 3, v138
    v_add_u32 v138, s48, v138
    v_add_u32 v138, 0x20000, v138
    v_xor_b32 v139, 64, v138
    v_cmp_gt_u32 vcc, 0x120, v0
    s_waitcnt vmcnt(0)
    s_lshl_b32 s96, s45, 12
    s_lshl_b32 s95, s52, 8
    s_add_u32 s96, s96, s95
    s_add_u32 s96, s96, 65664
    s_mov_b64 exec, 1
    buffer_store_dword v13, v11, s[36:39], s96 offen sc1
    s_mov_b64 exec, -1
    s_setprio 0
    s_add_u32 m0, s48, 147456
    s_mul_i32 s50, s89, 14336
    s_add_u32 s50, s50, s47
    buffer_load_dwordx4 v6, s[64:67], s50 offen offset:0 lds
    buffer_load_dwordx4 v7, s[64:67], s50 offen offset:1024 lds
    buffer_load_dwordx4 v8, s[64:67], s50 offen offset:2048 lds
    buffer_load_dwordx4 v9, s[64:67], s50 offen offset:3072 lds
    s_add_u32 m0, s48, 65536
    s_mul_i32 s50, s90, 14336
    s_add_u32 s50, s50, s47
    buffer_load_dwordx4 v6, s[64:67], s50 offen offset:0 lds
    buffer_load_dwordx4 v7, s[64:67], s50 offen offset:1024 lds
    buffer_load_dwordx4 v8, s[64:67], s50 offen offset:2048 lds
    buffer_load_dwordx4 v9, s[64:67], s50 offen offset:3072 lds
    s_add_u32 m0, s48, 81920
    s_mul_i32 s50, s91, 14336
    s_add_u32 s50, s50, s47
    buffer_load_dwordx4 v6, s[64:67], s50 offen offset:0 lds
    buffer_load_dwordx4 v7, s[64:67], s50 offen offset:1024 lds
    buffer_load_dwordx4 v8, s[64:67], s50 offen offset:2048 lds
    buffer_load_dwordx4 v9, s[64:67], s50 offen offset:3072 lds
    s_barrier
    s_setprio 1
    s_add_u32 m0, s48, 98304
    s_mul_i32 s50, s92, 14336
    s_add_u32 s50, s50, s47
    buffer_load_dwordx4 v6, s[64:67], s50 offen offset:0 lds
    buffer_load_dwordx4 v7, s[64:67], s50 offen offset:1024 lds
    buffer_load_dwordx4 v8, s[64:67], s50 offen offset:2048 lds
    buffer_load_dwordx4 v9, s[64:67], s50 offen offset:3072 lds
    s_add_u32 m0, s48, 114688
    s_mul_i32 s50, s93, 14336
    s_add_u32 s50, s50, s47
    buffer_load_dwordx4 v6, s[64:67], s50 offen offset:0 lds
    buffer_load_dwordx4 v7, s[64:67], s50 offen offset:1024 lds
    buffer_load_dwordx4 v8, s[64:67], s50 offen offset:2048 lds
    buffer_load_dwordx4 v9, s[64:67], s50 offen offset:3072 lds
    s_add_u32 m0, s48, 0
    s_mul_i32 s50, s94, 14336
    s_add_u32 s50, s50, s47
    buffer_load_dwordx4 v6, s[64:67], s50 offen offset:0 lds
    buffer_load_dwordx4 v7, s[64:67], s50 offen offset:1024 lds
    buffer_load_dwordx4 v8, s[64:67], s50 offen offset:2048 lds
    buffer_load_dwordx4 v9, s[64:67], s50 offen offset:3072 lds
    buffer_load_dword v15, v2, s[36:39], s98 offen sc1
    s_waitcnt vmcnt(0)
    s_mov_b32 s97, 0
POLL0:
    v_cmp_ne_u32 s[84:85], s14, v15
    s_nop 0
    s_cmp_lg_u64 s[84:85], 0
    s_cbranch_scc0 POLLOK0
    s_sleep 4
    s_add_u32 s97, s97, 1
    s_cmp_gt_u32 s97, 0x40000
    s_cbranch_scc1 K_END
    buffer_load_dword v15, v2, s[36:39], s98 offen sc1
    s_waitcnt vmcnt(0)
    s_branch POLL0
POLLOK0:
    s_lshl_b32 s51, s88, 10
    s_add_u32 s51, s51, s56
    buffer_load_dwordx4 a[0:3], v10, s[28:31], s51 offen offset:0 sc1
    buffer_load_dwordx4 a[8:11], v10, s[28:31], s51 offen offset:1024 sc1
    s_lshl_b32 s51, s88, 10
    s_add_u32 s51, s51, s57
    buffer_load_dwordx4 a[4:7], v10, s[28:31], s51 offen offset:0 sc1
    buffer_load_dwordx4 a[12:15], v10, s[28:31], s51 offen offset:1024 sc1
    s_lshl_b32 s51, s89, 10
    s_add_u32 s51, s51, s56
    buffer_load_dwordx4 a[16:19], v10, s[28:31], s51 offen offset:0 sc1
    buffer_load_dwordx4 a[24:27], v10, s[28:31], s51 offen offset:1024 sc1
    s_lshl_b32 s51, s89, 10
    s_add_u32 s51, s51, s57
    buffer_load_dwordx4 a[20:23], v10, s[28:31], s51 offen offset:0 sc1
    buffer_load_dwordx4 a[28:31], v10, s[28:31], s51 offen offset:1024 sc1
    s_barrier
    s_lshl_b32 s51, s90, 10
    s_add_u32 s51, s51, s56
    buffer_load_dwordx4 a[32:35], v10, s[28:31], s51 offen offset:0 sc1
    buffer_load_dwordx4 a[40:43], v10, s[28:31], s51 offen offset:1024 sc1
    s_lshl_b32 s51, s90, 10
    s_add_u32 s51, s51, s57
    buffer_load_dwordx4 a[36:39], v10, s[28:31], s51 offen offset:0 sc1
    buffer_load_dwordx4 a[44:47], v10, s[28:31], s51 offen offset:1024 sc1
    s_setprio 0
    ds_read_b64_tr_b16 v[80:81], v138 offset:0
    ds_read_b64_tr_b16 v[82:83], v138 offset:1024
    ds_read_b64_tr_b16 v[84:85], v139 offset:0
    ds_read_b64_tr_b16 v[86:87], v139 offset:1024
    ds_read_b64_tr_b16 v[88:89], v138 offset:2048
    ds_read_b64_tr_b16 v[90:91], v138 offset:3072
    ds_read_b64_tr_b16 v[92:93], v139 offset:2048
    ds_read_b64_tr_b16 v[94:95], v139 offset:3072
    s_waitcnt vmcnt(8)
    s_waitcnt lgkmcnt(4)
    v_mfma_f32_32x32x16_bf16 v[32:47], v[84:87], a[0:3], 0
    ds_read_b64_tr_b16 v[96:97], v138 offset:16384
    ds_read_b64_tr_b16 v[98:99], v138 offset:17408
    ds_read_b64_tr_b16 v[100:101], v139 offset:16384
    ds_read_b64_tr_b16 v[102:103], v139 offset:17408
    s_mul_i32 s95, s40, 56
    v_lshl_add_u32 v140, v14, 2, s95
    v_mfma_f32_32x32x16_bf16 v[48:63], v[80:83], a[4:7], 0
    v_cvt_f32_u32 v140, v140
    s_xor_b32 s95, s44, 0
    s_lshl_b32 s95, s95, 5
    s_lshl_b32 s96, s15, 6
    s_add_u32 s95, s95, s96
    v_add_u32 v3, s95, v12
    v_cvt_f32_u32 v4, v3
    v_mfma_f32_32x32x16_bf16 v[64:79], v[84:87], a[4:7], 0
    v_mul_f32 v4, 0x3b124925, v4
    v_mul_f32 v141, v4, v140
    v_fract_f32 v141, v141
    v_mfma_f32_32x32x16_bf16 v[16:31], v[80:83], a[0:3], 0
    v_mul_f32 v142, 0x41000000, v4
    v_cos_f32 v104, v141
    v_sin_f32 v105, v141
    s_waitcnt lgkmcnt(4)
    v_mfma_f32_32x32x16_bf16 v[32:47], v[92:95], a[8:11], v[32:47]
    ds_read_b64_tr_b16 v[80:81], v138 offset:18432
    ds_read_b64_tr_b16 v[82:83], v138 offset:19456
    ds_read_b64_tr_b16 v[84:85], v139 offset:18432
    ds_read_b64_tr_b16 v[86:87], v139 offset:19456
    v_add_f32 v143, v141, v4
    v_cos_f32 v106, v143
    v_sin_f32 v107, v143
    v_mfma_f32_32x32x16_bf16 v[48:63], v[88:91], a[12:15], v[48:63]
    v_add_f32 v143, v143, v4
    v_cos_f32 v108, v143
    v_sin_f32 v109, v143
    v_mfma_f32_32x32x16_bf16 v[64:79], v[92:95], a[12:15], v[64:79]
    v_add_f32 v143, v143, v4
    v_cos_f32 v110, v143
    v_sin_f32 v111, v143
    v_mfma_f32_32x32x16_bf16 v[16:31], v[88:91], a[8:11], v[16:31]
    v_add_f32 v143, v141, v142
    v_cos_f32 v112, v143
    v_sin_f32 v113, v143
    s_waitcnt vmcnt(4)
    s_waitcnt lgkmcnt(4)
    v_mfma_f32_32x32x16_bf16 v[32:47], v[100:103], a[16:19], v[32:47]
    v_add_u32 v138, 4294901760, v138
    v_add_u32 v139, 4294901760, v139
    ds_read_b64_tr_b16 v[88:89], v138 offset:0
    ds_read_b64_tr_b16 v[90:91], v138 offset:1024
    ds_read_b64_tr_b16 v[92:93], v139 offset:0
    ds_read_b64_tr_b16 v[94:95], v139 offset:1024
    v_add_f32 v143, v143, v4
    v_cos_f32 v114, v143
    v_sin_f32 v115, v143
    v_mfma_f32_32x32x16_bf16 v[48:63], v[96:99], a[20:23], v[48:63]
    v_add_f32 v143, v143, v4
    s_lshl_b32 s51, s91, 10
    s_add_u32 s51, s51, s56
    v_cos_f32 v116, v143
    v_sin_f32 v117, v143
    v_mfma_f32_32x32x16_bf16 v[64:79], v[100:103], a[20:23], v[64:79]
    v_add_f32 v143, v143, v4
    v_cos_f32 v118, v143
    buffer_load_dwordx4 a[48:51], v10, s[28:31], s51 offen offset:0 sc1
    v_mfma_f32_32x32x16_bf16 v[16:31], v[96:99], a[16:19], v[16:31]
    v_sin_f32 v119, v143
    v_cos_f32 v136, v142
    s_nop 0
    v_add_f32 v136, v136, v136
    s_xor_b32 s95, s44, 1
    s_lshl_b32 s95, s95, 5
    s_lshl_b32 s96, s15, 6
    s_add_u32 s95, s95, s96
    v_add_u32 v3, s95, v12
    s_waitcnt lgkmcnt(4)
    v_mfma_f32_32x32x16_bf16 v[32:47], v[84:87], a[24:27], v[32:47]
    ds_read_b64_tr_b16 v[96:97], v138 offset:2048
    ds_read_b64_tr_b16 v[98:99], v138 offset:3072
    ds_read_b64_tr_b16 v[100:101], v139 offset:2048
    ds_read_b64_tr_b16 v[102:103], v139 offset:3072
    buffer_load_dwordx4 a[0:3], v10, s[28:31], s51 offen offset:1024 sc1
    v_cvt_f32_u32 v4, v3
    v_mul_f32 v4, 0x3b124925, v4
    v_mul_f32 v141, v4, v140
    v_mfma_f32_32x32x16_bf16 v[48:63], v[80:83], a[28:31], v[48:63]
    v_fract_f32 v141, v141
    s_lshl_b32 s51, s91, 10
    s_add_u32 s51, s51, s57
    v_mul_f32 v142, 0x41000000, v4
    v_mfma_f32_32x32x16_bf16 v[64:79], v[84:87], a[28:31], v[64:79]
    v_cos_f32 v120, v141
    v_sin_f32 v121, v141
    v_add_f32 v143, v141, v4
    buffer_load_dwordx4 a[52:55], v10, s[28:31], s51 offen offset:0 sc1
    v_mfma_f32_32x32x16_bf16 v[16:31], v[80:83], a[24:27], v[16:31]
    v_cos_f32 v122, v143
    v_sin_f32 v123, v143
    v_add_f32 v143, v143, v4
    buffer_load_dwordx4 a[4:7], v10, s[28:31], s51 offen offset:1024 sc1
    s_waitcnt vmcnt(4)
    s_waitcnt lgkmcnt(4)
    v_mfma_f32_32x32x16_bf16 v[32:47], v[92:95], a[32:35], v[32:47]
    ds_read_b64_tr_b16 v[80:81], v138 offset:16384
    ds_read_b64_tr_b16 v[82:83], v138 offset:17408
    ds_read_b64_tr_b16 v[84:85], v139 offset:16384
    ds_read_b64_tr_b16 v[86:87], v139 offset:17408
    v_cos_f32 v124, v143
    v_sin_f32 v125, v143
    v_add_f32 v143, v143, v4
    v_mfma_f32_32x32x16_bf16 v[48:63], v[88:91], a[36:39], v[48:63]
    v_cos_f32 v126, v143
    s_lshl_b32 s51, s92, 10
    s_add_u32 s51, s51, s56
    v_sin_f32 v127, v143
    v_add_f32 v143, v141, v142
    v_mfma_f32_32x32x16_bf16 v[64:79], v[92:95], a[36:39], v[64:79]
    v_cos_f32 v128, v143
    v_sin_f32 v129, v143
    buffer_load_dwordx4 a[8:11], v10, s[28:31], s51 offen offset:0 sc1
    v_add_f32 v143, v143, v4
    v_mfma_f32_32x32x16_bf16 v[16:31], v[88:91], a[32:35], v[16:31]
    v_cos_f32 v130, v143
    v_sin_f32 v131, v143
    v_add_f32 v143, v143, v4
    buffer_load_dwordx4 a[16:19], v10, s[28:31], s51 offen offset:1024 sc1
    s_waitcnt lgkmcnt(4)
    v_mfma_f32_32x32x16_bf16 v[32:47], v[100:103], a[40:43], v[32:47]
    ds_read_b64_tr_b16 v[88:89], v138 offset:18432
    ds_read_b64_tr_b16 v[90:91], v138 offset:19456
    ds_read_b64_tr_b16 v[92:93], v139 offset:18432
    ds_read_b64_tr_b16 v[94:95], v139 offset:19456
    v_cos_f32 v132, v143
    v_sin_f32 v133, v143
    v_add_f32 v143, v143, v4
    v_cos_f32 v134, v143
    v_mfma_f32_32x32x16_bf16 v[48:63], v[96:99], a[44:47], v[48:63]
    s_lshl_b32 s51, s92, 10
    s_add_u32 s51, s51, s57
    v_sin_f32 v135, v143
    v_cos_f32 v137, v142
    s_nop 0
    v_add_f32 v137, v137, v137
    v_mfma_f32_32x32x16_bf16 v[64:79], v[100:103], a[44:47], v[64:79]
    v_lshlrev_b32 v141, 2, v12
    buffer_load_dwordx4 a[12:15], v10, s[28:31], s51 offen offset:0 sc1
    v_lshl_add_u32 v140, v14, 15, v141
    s_mul_i32 s95, s40, 458752
    s_lshl_b32 s45, s53, 7
    s_add_u32 s45, s45, s95
    s_lshl_b32 s52, s55, 7
    s_add_u32 s52, s52, s95
    v_mfma_f32_32x32x16_bf16 v[16:31], v[96:99], a[40:43], v[16:31]
    s_mul_i32 s95, s40, 56
    v_add_u32 v142, s95, v1
    v_cmp_gt_u32 s[84:85], 56, v1
    v_mov_b32 v143, 224
    s_nop 0
    v_cndmask_b32 v142, v143, v142, s[84:85]
    v_lshlrev_b32 v142, 5, v142
    s_lshr_b32 s59, s43, 3
    s_lshl_b32 s59, s59, 15
    s_add_u32 s59, s59, 327680
    buffer_load_dwordx4 a[20:23], v10, s[28:31], s51 offen offset:1024 sc1
    buffer_load_dword v143, v142, s[36:39], s59 offen sc1
    s_waitcnt vmcnt(5)
    s_waitcnt lgkmcnt(4)
    v_mfma_f32_32x32x16_bf16 v[32:47], v[84:87], a[48:51], v[32:47]
    ds_read_b64_tr_b16 v[96:97], v138 offset:32768
    ds_read_b64_tr_b16 v[98:99], v138 offset:33792
    ds_read_b64_tr_b16 v[100:101], v139 offset:32768
    ds_read_b64_tr_b16 v[102:103], v139 offset:33792
    v_mfma_f32_32x32x16_bf16 v[48:63], v[80:83], a[52:55], v[48:63]
    s_lshl_b32 s51, s93, 10
    s_add_u32 s51, s51, s56
    v_mfma_f32_32x32x16_bf16 v[64:79], v[84:87], a[52:55], v[64:79]
    buffer_load_dwordx4 a[24:27], v10, s[28:31], s51 offen offset:0 sc1
    v_mfma_f32_32x32x16_bf16 v[16:31], v[80:83], a[48:51], v[16:31]
    buffer_load_dwordx4 a[32:35], v10, s[28:31], s51 offen offset:1024 sc1
    s_waitcnt lgkmcnt(4)
    v_mfma_f32_32x32x16_bf16 v[32:47], v[92:95], a[0:3], v[32:47]
    ds_read_b64_tr_b16 v[80:81], v138 offset:34816
    ds_read_b64_tr_b16 v[82:83], v138 offset:35840
    ds_read_b64_tr_b16 v[84:85], v139 offset:34816
    ds_read_b64_tr_b16 v[86:87], v139 offset:35840
    v_mfma_f32_32x32x16_bf16 v[48:63], v[88:91], a[4:7], v[48:63]
    s_lshl_b32 s51, s93, 10
    s_add_u32 s51, s51, s57
    v_mfma_f32_32x32x16_bf16 v[64:79], v[92:95], a[4:7], v[64:79]
    buffer_load_dwordx4 a[28:31], v10, s[28:31], s51 offen offset:0 sc1
    v_mfma_f32_32x32x16_bf16 v[16:31], v[88:91], a[0:3], v[16:31]
    buffer_load_dwordx4 a[36:39], v10, s[28:31], s51 offen offset:1024 sc1
    s_waitcnt vmcnt(4)
    s_mov_b32 s97, 0
POLL1:
    v_cmp_ne_u32 s[84:85], s14, v143
    s_nop 0
    s_cmp_lg_u64 s[84:85], 0
    s_cbranch_scc0 POLLOK1
    s_sleep 4
    s_add_u32 s97, s97, 1
    s_cmp_gt_u32 s97, 0x40000
    s_cbranch_scc1 K_END
    buffer_load_dword v143, v142, s[36:39], s59 offen sc1
    s_waitcnt vmcnt(0)
    s_branch POLL1
POLLOK1:
    s_waitcnt lgkmcnt(4)
    v_mfma_f32_32x32x16_bf16 v[32:47], v[100:103], a[8:11], v[32:47]
    ds_read_b64_tr_b16 v[88:89], v138 offset:49152
    ds_read_b64_tr_b16 v[90:91], v138 offset:50176
    ds_read_b64_tr_b16 v[92:93], v139 offset:49152
    ds_read_b64_tr_b16 v[94:95], v139 offset:50176
    s_lshl_b32 s51, s94, 10
    s_add_u32 s51, s51, s56
    buffer_load_dwordx4 a[40:43], v10, s[28:31], s51 offen offset:0 sc1
    buffer_load_dwordx4 a[48:51], v10, s[28:31], s51 offen offset:1024 sc1
    v_mfma_f32_32x32x16_bf16 v[48:63], v[96:99], a[12:15], v[48:63]
    s_lshl_b32 s51, s94, 10
    s_add_u32 s51, s51, s57
    buffer_load_dwordx4 a[44:47], v10, s[28:31], s51 offen offset:0 sc1
    buffer_load_dwordx4 a[52:55], v10, s[28:31], s51 offen offset:1024 sc1
    v_mfma_f32_32x32x16_bf16 v[64:79], v[100:103], a[12:15], v[64:79]
    s_add_u32 s51, s45, 0
    buffer_load_dword v6, v140, s[68:71], s51 offen sc1
    s_add_u32 s51, s52, 0
    buffer_load_dword v7, v140, s[68:71], s51 offen sc1
    s_add_u32 s51, s45, 8192
    buffer_load_dword a57, v140, s[68:71], s51 offen sc1
    v_mfma_f32_32x32x16_bf16 v[16:31], v[96:99], a[8:11], v[16:31]
    s_add_u32 s51, s52, 8192
    buffer_load_dword a61, v140, s[68:71], s51 offen sc1
    s_add_u32 s51, s45, 16384
    buffer_load_dword a58, v140, s[68:71], s51 offen sc1
    s_add_u32 s51, s52, 16384
    buffer_load_dword a62, v140, s[68:71], s51 offen sc1
    s_waitcnt lgkmcnt(4)
    v_mfma_f32_32x32x16_bf16 v[32:47], v[84:87], a[16:19], v[32:47]
    ds_read_b64_tr_b16 v[96:97], v138 offset:51200
    ds_read_b64_tr_b16 v[98:99], v138 offset:52224
    ds_read_b64_tr_b16 v[100:101], v139 offset:51200
    ds_read_b64_tr_b16 v[102:103], v139 offset:52224
    s_add_u32 s51, s45, 24576
    buffer_load_dword a59, v140, s[68:71], s51 offen sc1
    s_add_u32 s51, s52, 24576
    buffer_load_dword a63, v140, s[68:71], s51 offen sc1
    s_lshl_b32 s51, s53, 7
    s_add_u32 s51, s51, 1835008
    buffer_load_dword v8, v141, s[68:71], s51 offen sc1
    v_mfma_f32_32x32x16_bf16 v[48:63], v[80:83], a[20:23], v[48:63]
    s_lshl_b32 s51, s55, 7
    s_add_u32 s51, s51, 1835008
    buffer_load_dword v9, v141, s[68:71], s51 offen sc1
    s_add_u32 s51, s45, 65536
    buffer_load_dword a64, v140, s[68:71], s51 offen sc1
    s_add_u32 s51, s52, 65536
    buffer_load_dword a68, v140, s[68:71], s51 offen sc1
    v_mfma_f32_32x32x16_bf16 v[64:79], v[84:87], a[20:23], v[64:79]
    s_add_u32 s51, s45, 73728
    buffer_load_dword a65, v140, s[68:71], s51 offen sc1
    s_add_u32 s51, s52, 73728
    buffer_load_dword a69, v140, s[68:71], s51 offen sc1
    s_add_u32 s51, s45, 81920
    buffer_load_dword a66, v140, s[68:71], s51 offen sc1
    v_mfma_f32_32x32x16_bf16 v[16:31], v[80:83], a[16:19], v[16:31]
    s_add_u32 s51, s52, 81920
    buffer_load_dword a70, v140, s[68:71], s51 offen sc1
    s_add_u32 s51, s45, 90112
    buffer_load_dword a67, v140, s[68:71], s51 offen sc1
    s_add_u32 s51, s52, 90112
    buffer_load_dword a71, v140, s[68:71], s51 offen sc1
    s_add_u32 s51, s45, 131072
    buffer_load_dword a72, v140, s[68:71], s51 offen sc1
    s_barrier
    s_waitcnt vmcnt(23)
    s_waitcnt lgkmcnt(4)
    v_mfma_f32_32x32x16_bf16 v[32:47], v[92:95], a[24:27], v[32:47]
    v_add_u32 v138, 4294901760, v138
    v_add_u32 v139, 4294901760, v139
    ds_read_b64_tr_b16 v[80:81], v138 offset:0
    ds_read_b64_tr_b16 v[82:83], v138 offset:1024
    ds_read_b64_tr_b16 v[84:85], v139 offset:0
    ds_read_b64_tr_b16 v[86:87], v139 offset:1024
    s_add_u32 s51, s52, 131072
    buffer_load_dword a76, v140, s[68:71], s51 offen sc1
    s_add_u32 s51, s45, 139264
    buffer_load_dword a73, v140, s[68:71], s51 offen sc1
    v_mfma_f32_32x32x16_bf16 v[48:63], v[88:91], a[28:31], v[48:63]
    s_add_u32 s51, s52, 139264
    buffer_load_dword a77, v140, s[68:71], s51 offen sc1
    s_add_u32 s51, s45, 147456
    buffer_load_dword a74, v140, s[68:71], s51 offen sc1
    v_mfma_f32_32x32x16_bf16 v[64:79], v[92:95], a[28:31], v[64:79]
    s_add_u32 s51, s52, 147456
    buffer_load_dword a78, v140, s[68:71], s51 offen sc1
    s_add_u32 s51, s45, 155648
    buffer_load_dword a75, v140, s[68:71], s51 offen sc1
    s_add_u32 s51, s52, 155648
    buffer_load_dword a79, v140, s[68:71], s51 offen sc1
    v_mfma_f32_32x32x16_bf16 v[16:31], v[88:91], a[24:27], v[16:31]
    s_add_u32 s51, s45, 196608
    buffer_load_dword a80, v140, s[68:71], s51 offen sc1
    s_add_u32 s51, s52, 196608
    buffer_load_dword a84, v140, s[68:71], s51 offen sc1
    s_waitcnt lgkmcnt(4)
    v_mfma_f32_32x32x16_bf16 v[32:47], v[100:103], a[32:35], v[32:47]
    ds_read_b64_tr_b16 v[88:89], v138 offset:2048
    ds_read_b64_tr_b16 v[90:91], v138 offset:3072
    ds_read_b64_tr_b16 v[92:93], v139 offset:2048
    ds_read_b64_tr_b16 v[94:95], v139 offset:3072
    s_add_u32 s51, s45, 204800
    buffer_load_dword a81, v140, s[68:71], s51 offen sc1
    s_add_u32 s51, s52, 204800
    buffer_load_dword a85, v140, s[68:71], s51 offen sc1
    v_mfma_f32_32x32x16_bf16 v[48:63], v[96:99], a[36:39], v[48:63]
    s_add_u32 s51, s45, 212992
    buffer_load_dword a82, v140, s[68:71], s51 offen sc1
    s_add_u32 s51, s52, 212992
    buffer_load_dword a86, v140, s[68:71], s51 offen sc1
    s_add_u32 s51, s45, 221184
    buffer_load_dword a83, v140, s[68:71], s51 offen sc1
    v_mfma_f32_32x32x16_bf16 v[64:79], v[100:103], a[36:39], v[64:79]
    s_add_u32 s51, s52, 221184
    buffer_load_dword a87, v140, s[68:71], s51 offen sc1
    s_add_u32 s51, s45, 262144
    buffer_load_dword a88, v140, s[68:71], s51 offen sc1
    v_mfma_f32_32x32x16_bf16 v[16:31], v[96:99], a[32:35], v[16:31]
    s_add_u32 s51, s52, 262144
    buffer_load_dword a92, v140, s[68:71], s51 offen sc1
    s_add_u32 s51, s45, 270336
    buffer_load_dword a89, v140, s[68:71], s51 offen sc1
    s_add_u32 s51, s52, 270336
    buffer_load_dword a93, v140, s[68:71], s51 offen sc1
    s_waitcnt vmcnt(38)
    s_waitcnt lgkmcnt(4)
    v_mfma_f32_32x32x16_bf16 v[32:47], v[84:87], a[40:43], v[32:47]
    s_add_u32 s51, s45, 278528
    buffer_load_dword a90, v140, s[68:71], s51 offen sc1
    s_add_u32 s51, s52, 278528
    buffer_load_dword a94, v140, s[68:71], s51 offen sc1
    v_mfma_f32_32x32x16_bf16 v[48:63], v[80:83], a[44:47], v[48:63]
    s_add_u32 s51, s45, 286720
    buffer_load_dword a91, v140, s[68:71], s51 offen sc1
    s_add_u32 s51, s52, 286720
    buffer_load_dword a95, v140, s[68:71], s51 offen sc1
    s_add_u32 s51, s45, 327680
    buffer_load_dword a96, v140, s[68:71], s51 offen sc1
    v_mfma_f32_32x32x16_bf16 v[64:79], v[84:87], a[44:47], v[64:79]
    s_add_u32 s51, s52, 327680
    buffer_load_dword a100, v140, s[68:71], s51 offen sc1
    s_add_u32 s51, s45, 335872
    buffer_load_dword a97, v140, s[68:71], s51 offen sc1
    v_mfma_f32_32x32x16_bf16 v[16:31], v[80:83], a[40:43], v[16:31]
    s_add_u32 s51, s52, 335872
    buffer_load_dword a101, v140, s[68:71], s51 offen sc1
    s_add_u32 s51, s45, 344064
    buffer_load_dword a98, v140, s[68:71], s51 offen sc1
    s_add_u32 s51, s52, 344064
    buffer_load_dword a102, v140, s[68:71], s51 offen sc1
    s_waitcnt lgkmcnt(0)
    v_mfma_f32_32x32x16_bf16 v[32:47], v[92:95], a[48:51], v[32:47]
    s_add_u32 s51, s45, 352256
    buffer_load_dword a99, v140, s[68:71], s51 offen sc1
    s_add_u32 s51, s52, 352256
    buffer_load_dword a103, v140, s[68:71], s51 offen sc1
    v_mfma_f32_32x32x16_bf16 v[48:63], v[88:91], a[52:55], v[48:63]
    s_add_u32 s51, s45, 393216
    buffer_load_dword a104, v140, s[68:71], s51 offen sc1
    s_add_u32 s51, s52, 393216
    buffer_load_dword a108, v140, s[68:71], s51 offen sc1
    s_add_u32 s51, s45, 401408
    buffer_load_dword a105, v140, s[68:71], s51 offen sc1
    v_mfma_f32_32x32x16_bf16 v[64:79], v[92:95], a[52:55], v[64:79]
    s_add_u32 s51, s52, 401408
    buffer_load_dword a109, v140, s[68:71], s51 offen sc1
    s_add_u32 s51, s45, 409600
    buffer_load_dword a106, v140, s[68:71], s51 offen sc1
    v_mfma_f32_32x32x16_bf16 v[16:31], v[88:91], a[48:51], v[16:31]
    s_add_u32 s51, s52, 409600
    buffer_load_dword a110, v140, s[68:71], s51 offen sc1
    s_add_u32 s51, s45, 417792
    buffer_load_dword a107, v140, s[68:71], s51 offen sc1
    s_add_u32 s51, s52, 417792
    buffer_load_dword a111, v140, s[68:71], s51 offen sc1
    s_add_u32 s16, s12, 15728640
    s_addc_u32 s17, s13, 0
    s_mov_b32 s18, 2097152
    s_mov_b32 s19, 0x20000
    v_cvt_pk_bf16_f32 v96, v104, v105
    v_cvt_pk_bf16_f32 v97, v106, v107
    v_cvt_pk_bf16_f32 v98, v108, v109
    v_cvt_pk_bf16_f32 v99, v110, v111
    v_cvt_pk_bf16_f32 v100, v120, v121
    v_cvt_pk_bf16_f32 v101, v122, v123
    v_cvt_pk_bf16_f32 v102, v124, v125
    v_cvt_pk_bf16_f32 v103, v126, v127
    v_lshlrev_b32 v3, 31, v12
    v_or_b32 v3, 0x3f003f00, v3
    v_cndmask_b32 v96, v96, v3, vcc
    v_cndmask_b32 v100, v100, v3, vcc
    s_waitcnt vmcnt(48)
    s_mov_b32 s95, 0x05040100
    v_perm_b32 v8, v8, v6, s95
    v_cndmask_b32 v6, v6, v8, vcc
    v_accvgpr_write_b32 a56, v6
    v_perm_b32 v9, v9, v7, s95
    v_cndmask_b32 v7, v7, v9, vcc
    v_accvgpr_write_b32 a60, v7
    v_mfma_f32_32x32x16_bf16 v[32:47], v[100:103], a[56:59], v[32:47]
    v_cvt_pk_bf16_f32 v80, v112, v113
    v_cvt_pk_bf16_f32 v81, v114, v115
    v_mfma_f32_32x32x16_bf16 v[48:63], v[96:99], a[60:63], v[48:63]
    v_cvt_pk_bf16_f32 v82, v116, v117
    v_cvt_pk_bf16_f32 v83, v118, v119
    v_mfma_f32_32x32x16_bf16 v[64:79], v[100:103], a[60:63], v[64:79]
    v_cvt_pk_bf16_f32 v84, v128, v129
    v_cvt_pk_bf16_f32 v85, v130, v131
    v_mfma_f32_32x32x16_bf16 v[16:31], v[96:99], a[56:59], v[16:31]
    v_cvt_pk_bf16_f32 v86, v132, v133
    v_cvt_pk_bf16_f32 v87, v134, v135
    s_waitcnt vmcnt(40)
    s_nop 0
    v_mfma_f32_32x32x16_bf16 v[32:47], v[84:87], a[64:67], v[32:47]
    v_fma_f32 v104, v136, v112, -v104
    v_fma_f32 v105, v136, v113, -v105
    v_fma_f32 v106, v136, v114, -v106
    v_fma_f32 v107, v136, v115, -v107
    v_fma_f32 v108, v136, v116, -v108
    v_fma_f32 v109, v136, v117, -v109
    v_mfma_f32_32x32x16_bf16 v[48:63], v[80:83], a[68:71], v[48:63]
    v_fma_f32 v110, v136, v118, -v110
    v_fma_f32 v111, v136, v119, -v111
    v_cvt_pk_bf16_f32 v88, v104, v105
    v_cvt_pk_bf16_f32 v89, v106, v107
    v_cvt_pk_bf16_f32 v90, v108, v109
    v_cvt_pk_bf16_f32 v91, v110, v111
    v_mfma_f32_32x32x16_bf16 v[64:79], v[84:87], a[68:71], v[64:79]
    v_fma_f32 v120, v137, v128, -v120
    v_fma_f32 v121, v137, v129, -v121
    v_fma_f32 v122, v137, v130, -v122
    v_fma_f32 v123, v137, v131, -v123
    v_fma_f32 v124, v137, v132, -v124
    v_fma_f32 v125, v137, v133, -v125
    v_mfma_f32_32x32x16_bf16 v[16:31], v[80:83], a[64:67], v[16:31]
    v_fma_f32 v126, v137, v134, -v126
    v_fma_f32 v127, v137, v135, -v127
    v_cvt_pk_bf16_f32 v92, v120, v121
    v_cvt_pk_bf16_f32 v93, v122, v123
    v_cvt_pk_bf16_f32 v94, v124, v125
    v_cvt_pk_bf16_f32 v95, v126, v127
    s_waitcnt vmcnt(32)
    s_lshl_b32 s58, s2, 2
    s_add_u32 s58, s58, s40
    s_lshl_b32 s57, s58, 11
    s_lshl_b32 s58, s58, 7
    s_add_u32 s58, s58, 655360
    buffer_load_dword v143, v11, s[36:39], s58 offen sc1
    v_mfma_f32_32x32x16_bf16 v[32:47], v[92:95], a[72:75], v[32:47]
    v_fma_f32 v112, v136, v104, -v112
    v_fma_f32 v113, v136, v105, -v113
    v_fma_f32 v114, v136, v106, -v114
    v_fma_f32 v115, v136, v107, -v115
    v_fma_f32 v116, v136, v108, -v116
    v_fma_f32 v117, v136, v109, -v117
    v_mfma_f32_32x32x16_bf16 v[48:63], v[88:91], a[76:79], v[48:63]
    v_fma_f32 v118, v136, v110, -v118
    v_fma_f32 v119, v136, v111, -v119
    v_cvt_pk_bf16_f32 v96, v112, v113
    v_cvt_pk_bf16_f32 v97, v114, v115
    v_cvt_pk_bf16_f32 v98, v116, v117
    v_cvt_pk_bf16_f32 v99, v118, v119
    v_mfma_f32_32x32x16_bf16 v[64:79], v[92:95], a[76:79], v[64:79]
    v_fma_f32 v128, v137, v120, -v128
    v_fma_f32 v129, v137, v121, -v129
    v_fma_f32 v130, v137, v122, -v130
    v_fma_f32 v131, v137, v123, -v131
    v_fma_f32 v132, v137, v124, -v132
    v_fma_f32 v133, v137, v125, -v133
    v_mfma_f32_32x32x16_bf16 v[16:31], v[88:91], a[72:75], v[16:31]
    v_fma_f32 v134, v137, v126, -v134
    v_fma_f32 v135, v137, v127, -v135
    v_cvt_pk_bf16_f32 v100, v128, v129
    v_cvt_pk_bf16_f32 v101, v130, v131
    v_cvt_pk_bf16_f32 v102, v132, v133
    v_cvt_pk_bf16_f32 v103, v134, v135
    s_waitcnt vmcnt(25)
    s_nop 0
    v_mfma_f32_32x32x16_bf16 v[32:47], v[100:103], a[80:83], v[32:47]
    v_fma_f32 v104, v136, v112, -v104
    v_fma_f32 v105, v136, v113, -v105
    v_fma_f32 v106, v136, v114, -v106
    v_fma_f32 v107, v136, v115, -v107
    v_fma_f32 v108, v136, v116, -v108
    v_fma_f32 v109, v136, v117, -v109
    v_mfma_f32_32x32x16_bf16 v[48:63], v[96:99], a[84:87], v[48:63]
    v_fma_f32 v110, v136, v118, -v110
    v_fma_f32 v111, v136, v119, -v111
    v_cvt_pk_bf16_f32 v80, v104, v105
    v_cvt_pk_bf16_f32 v81, v106, v107
    v_cvt_pk_bf16_f32 v82, v108, v109
    v_cvt_pk_bf16_f32 v83, v110, v111
    v_mfma_f32_32x32x16_bf16 v[64:79], v[100:103], a[84:87], v[64:79]
    v_fma_f32 v120, v137, v128, -v120
    v_fma_f32 v121, v137, v129, -v121
    v_fma_f32 v122, v137, v130, -v122
    v_fma_f32 v123, v137, v131, -v123
    v_fma_f32 v124, v137, v132, -v124
    v_fma_f32 v125, v137, v133, -v125
    v_mfma_f32_32x32x16_bf16 v[16:31], v[96:99], a[80:83], v[16:31]
    v_fma_f32 v126, v137, v134, -v126
    v_fma_f32 v127, v137, v135, -v127
    v_cvt_pk_bf16_f32 v84, v120, v121
    v_cvt_pk_bf16_f32 v85, v122, v123
    v_cvt_pk_bf16_f32 v86, v124, v125
    v_cvt_pk_bf16_f32 v87, v126, v127
    s_waitcnt vmcnt(17)
    s_nop 0
    v_mfma_f32_32x32x16_bf16 v[32:47], v[84:87], a[88:91], v[32:47]
    v_fma_f32 v112, v136, v104, -v112
    v_fma_f32 v113, v136, v105, -v113
    v_fma_f32 v114, v136, v106, -v114
    v_fma_f32 v115, v136, v107, -v115
    v_fma_f32 v116, v136, v108, -v116
    v_fma_f32 v117, v136, v109, -v117
    v_mfma_f32_32x32x16_bf16 v[48:63], v[80:83], a[92:95], v[48:63]
    v_fma_f32 v118, v136, v110, -v118
    v_fma_f32 v119, v136, v111, -v119
    v_cvt_pk_bf16_f32 v88, v112, v113
    v_cvt_pk_bf16_f32 v89, v114, v115
    v_cvt_pk_bf16_f32 v90, v116, v117
    v_cvt_pk_bf16_f32 v91, v118, v119
    v_mfma_f32_32x32x16_bf16 v[64:79], v[84:87], a[92:95], v[64:79]
    v_fma_f32 v128, v137, v120, -v128
    v_fma_f32 v129, v137, v121, -v129
    v_fma_f32 v130, v137, v122, -v130
    v_fma_f32 v131, v137, v123, -v131
    v_fma_f32 v132, v137, v124, -v132
    v_fma_f32 v133, v137, v125, -v133
    v_mfma_f32_32x32x16_bf16 v[16:31], v[80:83], a[88:91], v[16:31]
    v_fma_f32 v134, v137, v126, -v134
    v_fma_f32 v135, v137, v127, -v135
    v_cvt_pk_bf16_f32 v92, v128, v129
    v_cvt_pk_bf16_f32 v93, v130, v131
    v_cvt_pk_bf16_f32 v94, v132, v133
    v_cvt_pk_bf16_f32 v95, v134, v135
    s_waitcnt vmcnt(9)
    s_waitcnt vmcnt(0)
    s_mov_b32 s97, 0
POLL2:
    v_cmp_ne_u32 s[84:85], s14, v143
    s_nop 0
    s_cmp_lg_u64 s[84:85], 0
    s_cbranch_scc0 POLLOK2
    s_sleep 4
    s_add_u32 s97, s97, 1
    s_cmp_gt_u32 s97, 0x40000
    s_cbranch_scc1 K_END
    buffer_load_dword v143, v11, s[36:39], s58 offen sc1
    s_waitcnt vmcnt(0)
    s_branch POLL2
POLLOK2:
    buffer_load_dwordx4 a[0:3], v10, s[16:19], s57 offen offset:0 sc1
    buffer_load_dwordx4 a[4:7], v10, s[16:19], s57 offen offset:1024 sc1
    v_mfma_f32_32x32x16_bf16 v[32:47], v[92:95], a[96:99], v[32:47]
    v_fma_f32 v104, v136, v112, -v104
    v_fma_f32 v105, v136, v113, -v105
    v_fma_f32 v106, v136, v114, -v106
    v_fma_f32 v107, v136, v115, -v107
    v_fma_f32 v108, v136, v116, -v108
    v_fma_f32 v109, v136, v117, -v109
    v_mfma_f32_32x32x16_bf16 v[48:63], v[88:91], a[100:103], v[48:63]
    v_fma_f32 v110, v136, v118, -v110
    v_fma_f32 v111, v136, v119, -v111
    v_cvt_pk_bf16_f32 v96, v104, v105
    v_cvt_pk_bf16_f32 v97, v106, v107
    v_cvt_pk_bf16_f32 v98, v108, v109
    v_cvt_pk_bf16_f32 v99, v110, v111
    v_mfma_f32_32x32x16_bf16 v[64:79], v[92:95], a[100:103], v[64:79]
    v_fma_f32 v120, v137, v128, -v120
    v_fma_f32 v121, v137, v129, -v121
    v_fma_f32 v122, v137, v130, -v122
    v_fma_f32 v123, v137, v131, -v123
    v_fma_f32 v124, v137, v132, -v124
    v_fma_f32 v125, v137, v133, -v125
    v_mfma_f32_32x32x16_bf16 v[16:31], v[88:91], a[96:99], v[16:31]
    v_fma_f32 v126, v137, v134, -v126
    v_fma_f32 v127, v137, v135, -v127
    v_cvt_pk_bf16_f32 v100, v120, v121
    v_cvt_pk_bf16_f32 v101, v122, v123
    v_cvt_pk_bf16_f32 v102, v124, v125
    v_cvt_pk_bf16_f32 v103, v126, v127
    s_nop 1
    v_mfma_f32_32x32x16_bf16 v[32:47], v[100:103], a[104:107], v[32:47]
    v_and_b32 v4, 3, v12
    v_mfma_f32_32x32x16_bf16 v[48:63], v[96:99], a[108:111], v[48:63]
    v_lshrrev_b32 v6, 2, v12
    v_lshl_add_u32 v6, v4, 5, v6
    v_mfma_f32_32x32x16_bf16 v[64:79], v[100:103], a[108:111], v[64:79]
    v_mul_u32_u24 v6, 896, v6
    v_mfma_f32_32x32x16_bf16 v[16:31], v[96:99], a[104:107], v[16:31]
    v_lshl_add_u32 v6, v14, 4, v6
    s_lshr_b32 s59, s53, 2
    s_lshl_b32 s59, s59, 7
    s_and_b32 s95, s53, 3
    s_lshl_b32 s95, s95, 3
    s_add_u32 s59, s59, s95
    s_mul_i32 s59, s59, 896
    s_add_u32 s59, s59, s47
    s_lshl_b32 s96, s44, 6
    s_add_u32 s59, s59, s96
    v_add_u32 v3, s48, v10
    v_add_u32 v3, 0x10000, v3
    ds_write_b128 v3, v[32:35] offset:0
    ds_write_b128 v3, v[36:39] offset:1024
    ds_write_b128 v3, v[40:43] offset:2048
    ds_write_b128 v3, v[44:47] offset:3072
    ds_write_b128 v3, v[48:51] offset:16384
    ds_write_b128 v3, v[52:55] offset:17408
    ds_write_b128 v3, v[56:59] offset:18432
    ds_write_b128 v3, v[60:63] offset:19456
    ds_write_b128 v3, v[64:67] offset:32768
    ds_write_b128 v3, v[68:71] offset:33792
    ds_write_b128 v3, v[72:75] offset:34816
    ds_write_b128 v3, v[76:79] offset:35840
    s_xor_b32 s95, s40, 1
    s_lshl_b32 s95, s95, 12
    s_add_u32 s95, s95, 65536
    v_add_u32 v140, s95, v10
    s_xor_b32 s95, s40, 2
    s_lshl_b32 s95, s95, 12
    s_add_u32 s95, s95, 81920
    v_add_u32 v141, s95, v10
    s_xor_b32 s95, s40, 3
    s_lshl_b32 s95, s95, 12
    s_add_u32 s95, s95, 98304
    v_add_u32 v142, s95, v10
    s_waitcnt vmcnt(0)
    v_accvgpr_read_b32 v128, a0
    v_accvgpr_read_b32 v129, a1
    v_accvgpr_read_b32 v130, a2
    v_accvgpr_read_b32 v131, a3
    v_accvgpr_read_b32 v132, a4
    v_accvgpr_read_b32 v133, a5
    v_accvgpr_read_b32 v134, a6
    v_accvgpr_read_b32 v135, a7
    v_lshlrev_b32 v80, 16, v128
    v_and_b32 v81, 0xffff0000, v128
    v_lshlrev_b32 v82, 16, v129
    v_and_b32 v83, 0xffff0000, v129
    v_lshlrev_b32 v84, 16, v130
    v_and_b32 v85, 0xffff0000, v130
    v_lshlrev_b32 v86, 16, v131
    v_and_b32 v87, 0xffff0000, v131
    v_lshlrev_b32 v88, 16, v132
    v_and_b32 v89, 0xffff0000, v132
    v_lshlrev_b32 v90, 16, v133
    v_and_b32 v91, 0xffff0000, v133
    v_lshlrev_b32 v92, 16, v134
    v_and_b32 v93, 0xffff0000, v134
    v_lshlrev_b32 v94, 16, v135
    v_and_b32 v95, 0xffff0000, v135
    v_pk_add_f32 v[16:17], v[16:17], v[80:81]
    v_pk_add_f32 v[18:19], v[18:19], v[82:83]
    v_pk_add_f32 v[20:21], v[20:21], v[84:85]
    v_pk_add_f32 v[22:23], v[22:23], v[86:87]
    v_pk_add_f32 v[24:25], v[24:25], v[88:89]
    v_pk_add_f32 v[26:27], v[26:27], v[90:91]
    v_pk_add_f32 v[28:29], v[28:29], v[92:93]
    v_pk_add_f32 v[30:31], v[30:31], v[94:95]
    s_waitcnt lgkmcnt(0)
    s_barrier
    ds_read_b128 v[32:35], v140 offset:0
    ds_read_b128 v[36:39], v140 offset:1024
    ds_read_b128 v[40:43], v140 offset:2048
    ds_read_b128 v[44:47], v140 offset:3072
    ds_read_b128 v[48:51], v141 offset:0
    ds_read_b128 v[52:55], v141 offset:1024
    ds_read_b128 v[56:59], v141 offset:2048
    ds_read_b128 v[60:63], v141 offset:3072
    ds_read_b128 v[64:67], v142 offset:0
    ds_read_b128 v[68:71], v142 offset:1024
    ds_read_b128 v[72:75], v142 offset:2048
    ds_read_b128 v[76:79], v142 offset:3072
    s_waitcnt lgkmcnt(8)
    v_pk_add_f32 v[16:17], v[16:17], v[32:33]
    v_pk_add_f32 v[18:19], v[18:19], v[34:35]
    v_pk_add_f32 v[20:21], v[20:21], v[36:37]
    v_pk_add_f32 v[22:23], v[22:23], v[38:39]
    v_pk_add_f32 v[24:25], v[24:25], v[40:41]
    v_pk_add_f32 v[26:27], v[26:27], v[42:43]
    v_pk_add_f32 v[28:29], v[28:29], v[44:45]
    v_pk_add_f32 v[30:31], v[30:31], v[46:47]
    s_waitcnt lgkmcnt(4)
    v_pk_add_f32 v[16:17], v[16:17], v[48:49]
    v_pk_add_f32 v[18:19], v[18:19], v[50:51]
    v_pk_add_f32 v[20:21], v[20:21], v[52:53]
    v_pk_add_f32 v[22:23], v[22:23], v[54:55]
    v_pk_add_f32 v[24:25], v[24:25], v[56:57]
    v_pk_add_f32 v[26:27], v[26:27], v[58:59]
    v_pk_add_f32 v[28:29], v[28:29], v[60:61]
    v_pk_add_f32 v[30:31], v[30:31], v[62:63]
    s_waitcnt lgkmcnt(0)
    v_pk_add_f32 v[16:17], v[16:17], v[64:65]
    v_pk_add_f32 v[18:19], v[18:19], v[66:67]
    v_pk_add_f32 v[20:21], v[20:21], v[68:69]
    v_pk_add_f32 v[22:23], v[22:23], v[70:71]
    v_pk_add_f32 v[24:25], v[24:25], v[72:73]
    v_pk_add_f32 v[26:27], v[26:27], v[74:75]
    v_pk_add_f32 v[28:29], v[28:29], v[76:77]
    v_pk_add_f32 v[30:31], v[30:31], v[78:79]
    v_cvt_pk_bf16_f32 v128, v16, v17
    v_cvt_pk_bf16_f32 v129, v18, v19
    v_cvt_pk_bf16_f32 v130, v20, v21
    v_cvt_pk_bf16_f32 v131, v22, v23
    v_cvt_pk_bf16_f32 v132, v24, v25
    v_cvt_pk_bf16_f32 v133, v26, v27
    v_cvt_pk_bf16_f32 v134, v28, v29
    v_cvt_pk_bf16_f32 v135, v30, v31
    v_permlane32_swap_b32 v128, v130
    v_permlane32_swap_b32 v129, v131
    buffer_store_dwordx4 v[128:131], v6, s[80:83], s59 offen offset:0
    v_permlane32_swap_b32 v132, v134
    v_permlane32_swap_b32 v133, v135
    buffer_store_dwordx4 v[132:135], v6, s[80:83], s59 offen offset:32
    s_or_b32 s95, s2, s40
    s_cmp_eq_u32 s95, 0
    s_cbranch_scc0 K_FIN
    s_mov_b32 s96, 61440
    s_mov_b64 exec, 1
    buffer_store_dword v13, v11, s[36:39], s96 offen sc1
    s_mov_b64 exec, -1
K_FIN:
    s_endpgm
K_G0:
    v_lshlrev_b32 v10, 4, v1
    v_mov_b32 v11, 0
    v_mov_b32 v15, 0
    v_and_b32 v12, 31, v1
    v_lshrrev_b32 v14, 5, v1
    s_lshr_b32 s88, s41, 1
    s_and_b32 s95, s41, 1
    s_lshl_b32 s95, s95, 1
    s_add_u32 s88, s88, s95
    s_lshr_b32 s95, s15, 2
    s_add_u32 s88, s88, s95
    s_and_b32 s88, s88, 3
    s_lshl_b32 s88, s88, 1
    s_cmp_ge_u32 s88, 7
    s_cselect_b32 s95, 7, 0
    s_sub_u32 s88, s88, s95
    v_and_b32 v16, 15, v1
    s_lshl_b32 s52, s44, 4
    v_add_u32 v16, s52, v16
    v_bfe_u32 v3, v1, 4, 1
    v_lshl_add_u32 v4, v16, 1, v3
    v_cmp_eq_u32 vcc, 1, v4
    v_mov_b32 v17, 224
    s_nop 0
    v_cndmask_b32 v16, v16, v17, vcc
    v_cndmask_b32 v3, v3, 0, vcc
    v_cvt_f32_u32 v16, v16
    v_cvt_f32_u32 v3, v3
    v_mul_f32 v16, 0x3b124925, v16
    v_mul_f32 v3, 0x3e800000, v3
    s_lshl_b32 s52, s88, 6
    s_lshl_b32 s95, s40, 4
    s_add_u32 s52, s52, s95
    v_lshl_add_u32 v4, v14, 3, s52
    v_cvt_f32_u32 v4, v4
    v_fma_f32 v64, v4, v16, v3
    v_fract_f32 v64, v64
    v_add_f32 v65, v64, v16
    v_add_f32 v66, v65, v16
    v_add_f32 v67, v66, v16
    v_add_f32 v68, v67, v16
    v_add_f32 v69, v68, v16
    v_add_f32 v70, v69, v16
    v_add_f32 v71, v70, v16
    v_mul_f32 v4, 0x42800000, v16
    v_fract_f32 v4, v4
    v_add_f32 v72, v64, v4
    v_add_f32 v73, v65, v4
    v_add_f32 v74, v66, v4
    v_add_f32 v75, v67, v4
    v_add_f32 v76, v68, v4
    v_add_f32 v77, v69, v4
    v_add_f32 v78, v70, v4
    v_add_f32 v79, v71, v4
    v_cos_f32 v64, v64
    v_cos_f32 v65, v65
    v_cos_f32 v66, v66
    v_cos_f32 v67, v67
    v_cos_f32 v68, v68
    v_cos_f32 v69, v69
    v_cos_f32 v70, v70
    v_cos_f32 v71, v71
    v_cos_f32 v72, v72
    v_cos_f32 v73, v73
    v_cos_f32 v74, v74
    v_cos_f32 v75, v75
    v_cos_f32 v76, v76
    v_cos_f32 v77, v77
    v_cos_f32 v78, v78
    v_cos_f32 v79, v79
    v_cos_f32 v80, v4
    s_nop 0
    v_add_f32 v80, v80, v80
    v_mov_b32 v81, v80
    v_lshl_add_u32 v82, v2, 10, v10
    v_add_u32 v82, 81920, v82
    v_cvt_pk_bf16_f32 v84, v64, v65
    v_cvt_pk_bf16_f32 v85, v66, v67
    v_cvt_pk_bf16_f32 v86, v68, v69
    v_cvt_pk_bf16_f32 v87, v70, v71
    ds_write_b128 v82, v[84:87] offset:0
    v_cvt_pk_bf16_f32 v88, v72, v73
    v_cvt_pk_bf16_f32 v89, v74, v75
    v_cvt_pk_bf16_f32 v90, v76, v77
    v_cvt_pk_bf16_f32 v91, v78, v79
    ds_write_b128 v82, v[88:91] offset:4096
    v_pk_fma_f32 v[64:65], v[80:81], v[72:73], v[64:65] neg_lo:[0,0,1] neg_hi:[0,0,1]
    v_pk_fma_f32 v[66:67], v[80:81], v[74:75], v[66:67] neg_lo:[0,0,1] neg_hi:[0,0,1]
    v_pk_fma_f32 v[68:69], v[80:81], v[76:77], v[68:69] neg_lo:[0,0,1] neg_hi:[0,0,1]
    v_pk_fma_f32 v[70:71], v[80:81], v[78:79], v[70:71] neg_lo:[0,0,1] neg_hi:[0,0,1]
    v_cvt_pk_bf16_f32 v84, v64, v65
    v_cvt_pk_bf16_f32 v85, v66, v67
    v_cvt_pk_bf16_f32 v86, v68, v69
    v_cvt_pk_bf16_f32 v87, v70, v71
    ds_write_b128 v82, v[84:87] offset:8192
    v_pk_fma_f32 v[72:73], v[80:81], v[64:65], v[72:73] neg_lo:[0,0,1] neg_hi:[0,0,1]
    v_pk_fma_f32 v[74:75], v[80:81], v[66:67], v[74:75] neg_lo:[0,0,1] neg_hi:[0,0,1]
    v_pk_fma_f32 v[76:77], v[80:81], v[68:69], v[76:77] neg_lo:[0,0,1] neg_hi:[0,0,1]
    v_pk_fma_f32 v[78:79], v[80:81], v[70:71], v[78:79] neg_lo:[0,0,1] neg_hi:[0,0,1]
    v_cvt_pk_bf16_f32 v88, v72, v73
    v_cvt_pk_bf16_f32 v89, v74, v75
    v_cvt_pk_bf16_f32 v90, v76, v77
    v_cvt_pk_bf16_f32 v91, v78, v79
    ds_write_b128 v82, v[88:91] offset:12288
    v_pk_fma_f32 v[64:65], v[80:81], v[72:73], v[64:65] neg_lo:[0,0,1] neg_hi:[0,0,1]
    v_pk_fma_f32 v[66:67], v[80:81], v[74:75], v[66:67] neg_lo:[0,0,1] neg_hi:[0,0,1]
    v_pk_fma_f32 v[68:69], v[80:81], v[76:77], v[68:69] neg_lo:[0,0,1] neg_hi:[0,0,1]
    v_pk_fma_f32 v[70:71], v[80:81], v[78:79], v[70:71] neg_lo:[0,0,1] neg_hi:[0,0,1]
    v_cvt_pk_bf16_f32 v84, v64, v65
    v_cvt_pk_bf16_f32 v85, v66, v67
    v_cvt_pk_bf16_f32 v86, v68, v69
    v_cvt_pk_bf16_f32 v87, v70, v71
    ds_write_b128 v82, v[84:87] offset:16384
    v_pk_fma_f32 v[72:73], v[80:81], v[64:65], v[72:73] neg_lo:[0,0,1] neg_hi:[0,0,1]
    v_pk_fma_f32 v[74:75], v[80:81], v[66:67], v[74:75] neg_lo:[0,0,1] neg_hi:[0,0,1]
    v_pk_fma_f32 v[76:77], v[80:81], v[68:69], v[76:77] neg_lo:[0,0,1] neg_hi:[0,0,1]
    v_pk_fma_f32 v[78:79], v[80:81], v[70:71], v[78:79] neg_lo:[0,0,1] neg_hi:[0,0,1]
    v_cvt_pk_bf16_f32 v88, v72, v73
    v_cvt_pk_bf16_f32 v89, v74, v75
    v_cvt_pk_bf16_f32 v90, v76, v77
    v_cvt_pk_bf16_f32 v91, v78, v79
    ds_write_b128 v82, v[88:91] offset:20480
    v_pk_fma_f32 v[64:65], v[80:81], v[72:73], v[64:65] neg_lo:[0,0,1] neg_hi:[0,0,1]
    v_pk_fma_f32 v[66:67], v[80:81], v[74:75], v[66:67] neg_lo:[0,0,1] neg_hi:[0,0,1]
    v_pk_fma_f32 v[68:69], v[80:81], v[76:77], v[68:69] neg_lo:[0,0,1] neg_hi:[0,0,1]
    v_pk_fma_f32 v[70:71], v[80:81], v[78:79], v[70:71] neg_lo:[0,0,1] neg_hi:[0,0,1]
    v_cvt_pk_bf16_f32 v84, v64, v65
    v_cvt_pk_bf16_f32 v85, v66, v67
    v_cvt_pk_bf16_f32 v86, v68, v69
    v_cvt_pk_bf16_f32 v87, v70, v71
    ds_write_b128 v82, v[84:87] offset:24576
    s_waitcnt lgkmcnt(0)
    s_add_u32 s36, s12, 7340032
    s_addc_u32 s37, s13, 0
    s_load_dword s14, s[36:37], 61440
    s_barrier
    s_mov_b32 s24, s10
    s_mov_b32 s25, s11
    s_mov_b32 s26, 3584
    s_mov_b32 s27, 0x20000
    v_lshlrev_b32 v3, 1, v12
    buffer_load_ushort v104, v3, s[24:27], s47 offen offset:0
    buffer_load_ushort v108, v3, s[24:27], s47 offen offset:64
    s_mov_b32 s16, s62
    s_mov_b32 s17, s63
    s_mov_b32 s18, 896
    s_mov_b32 s19, 0x20000
    buffer_load_dword v126, v11, s[16:19], 0 offen
    s_mov_b32 s38, 1048576
    s_mov_b32 s39, 0x20000
    s_add_u32 s28, s12, 8388608
    s_addc_u32 s29, s13, 0
    s_mov_b32 s30, 7340032
    s_mov_b32 s31, 0x20000
    s_mov_b32 s32, s12
    s_mov_b32 s33, s13
    s_mov_b32 s34, 1835008
    s_mov_b32 s35, 0x20000
    s_mov_b32 s64, s60
    s_mov_b32 s65, s61
    s_mov_b32 s66, 1605632
    s_mov_b32 s67, 0x20000
    s_add_u32 s68, s12, 2097152
    s_addc_u32 s69, s13, 0
    s_mov_b32 s70, 1843200
    s_mov_b32 s71, 0x20000
    s_add_u32 s72, s12, 4194304
    s_addc_u32 s73, s13, 0
    s_mov_b32 s74, 1843200
    s_mov_b32 s75, 0x20000
    s_add_u32 s76, s12, 6291456
    s_addc_u32 s77, s13, 0
    s_mov_b32 s78, 229376
    s_mov_b32 s79, 0x20000
    s_mov_b32 s80, s6
    s_mov_b32 s81, s7
    s_mov_b32 s82, 1835008
    s_mov_b32 s83, 0x20000
    v_and_b32 v16, 15, v1
    v_lshrrev_b32 v17, 4, v1
    v_lshlrev_b32 v15, 9, v17
    v_lshl_add_u32 v15, v16, 4, v15
    v_lshl_add_u32 v18, v2, 4, v16
    v_cvt_f32_u32 v18, v18
    v_cvt_f32_u32 v19, v16
    v_lshlrev_b32 v20, 2, v17
    v_cvt_f32_u32 v20, v20
    v_mul_f32 v21, 0x3c800000, v18
    v_mul_f32 v22, v21, v20
    v_mul_f32 v23, 0x41800000, v21
    v_cos_f32 v25, v22
    v_sin_f32 v26, v22
    s_nop 0
    v_cvt_pk_bf16_f32 v27, v25, v26
    v_cvt_pk_bf16_f32 v28, -v26, v25
    v_accvgpr_write_b32 a64, v27
    v_accvgpr_write_b32 a80, v28
    v_add_f32 v24, v22, v21
    v_cos_f32 v25, v24
    v_sin_f32 v26, v24
    s_nop 0
    v_cvt_pk_bf16_f32 v27, v25, v26
    v_cvt_pk_bf16_f32 v28, -v26, v25
    v_accvgpr_write_b32 a65, v27
    v_accvgpr_write_b32 a81, v28
    v_add_f32 v24, v24, v21
    v_cos_f32 v25, v24
    v_sin_f32 v26, v24
    s_nop 0
    v_cvt_pk_bf16_f32 v27, v25, v26
    v_cvt_pk_bf16_f32 v28, -v26, v25
    v_accvgpr_write_b32 a66, v27
    v_accvgpr_write_b32 a82, v28
    v_add_f32 v24, v24, v21
    v_cos_f32 v25, v24
    v_sin_f32 v26, v24
    s_nop 0
    v_cvt_pk_bf16_f32 v27, v25, v26
    v_cvt_pk_bf16_f32 v28, -v26, v25
    v_accvgpr_write_b32 a67, v27
    v_accvgpr_write_b32 a83, v28
    v_add_f32 v22, v22, v23
    v_cos_f32 v25, v22
    v_sin_f32 v26, v22
    s_nop 0
    v_cvt_pk_bf16_f32 v27, v25, v26
    v_cvt_pk_bf16_f32 v28, -v26, v25
    v_accvgpr_write_b32 a68, v27
    v_accvgpr_write_b32 a84, v28
    v_add_f32 v24, v22, v21
    v_cos_f32 v25, v24
    v_sin_f32 v26, v24
    s_nop 0
    v_cvt_pk_bf16_f32 v27, v25, v26
    v_cvt_pk_bf16_f32 v28, -v26, v25
    v_accvgpr_write_b32 a69, v27
    v_accvgpr_write_b32 a85, v28
    v_add_f32 v24, v24, v21
    v_cos_f32 v25, v24
    v_sin_f32 v26, v24
    s_nop 0
    v_cvt_pk_bf16_f32 v27, v25, v26
    v_cvt_pk_bf16_f32 v28, -v26, v25
    v_accvgpr_write_b32 a70, v27
    v_accvgpr_write_b32 a86, v28
    s_barrier
    v_add_f32 v24, v24, v21
    v_cos_f32 v25, v24
    v_sin_f32 v26, v24
    s_nop 0
    v_cvt_pk_bf16_f32 v27, v25, v26
    v_cvt_pk_bf16_f32 v28, -v26, v25
    v_accvgpr_write_b32 a71, v27
    v_accvgpr_write_b32 a87, v28
    v_add_f32 v22, v22, v23
    v_cos_f32 v25, v22
    v_sin_f32 v26, v22
    s_nop 0
    v_cvt_pk_bf16_f32 v27, v25, v26
    v_cvt_pk_bf16_f32 v28, -v26, v25
    v_accvgpr_write_b32 a72, v27
    v_accvgpr_write_b32 a88, v28
    v_add_f32 v24, v22, v21
    v_cos_f32 v25, v24
    v_sin_f32 v26, v24
    s_nop 0
    v_cvt_pk_bf16_f32 v27, v25, v26
    v_cvt_pk_bf16_f32 v28, -v26, v25
    v_accvgpr_write_b32 a73, v27
    v_accvgpr_write_b32 a89, v28
    v_add_f32 v24, v24, v21
    v_cos_f32 v25, v24
    v_sin_f32 v26, v24
    s_nop 0
    v_cvt_pk_bf16_f32 v27, v25, v26
    v_cvt_pk_bf16_f32 v28, -v26, v25
    v_accvgpr_write_b32 a74, v27
    v_accvgpr_write_b32 a90, v28
    v_add_f32 v24, v24, v21
    v_cos_f32 v25, v24
    v_sin_f32 v26, v24
    s_nop 0
    v_cvt_pk_bf16_f32 v27, v25, v26
    v_cvt_pk_bf16_f32 v28, -v26, v25
    v_accvgpr_write_b32 a75, v27
    v_accvgpr_write_b32 a91, v28
    v_add_f32 v22, v22, v23
    v_cos_f32 v25, v22
    v_sin_f32 v26, v22
    s_nop 0
    v_cvt_pk_bf16_f32 v27, v25, v26
    v_cvt_pk_bf16_f32 v28, -v26, v25
    v_accvgpr_write_b32 a76, v27
    v_accvgpr_write_b32 a92, v28
    v_add_f32 v24, v22, v21
    v_cos_f32 v25, v24
    v_sin_f32 v26, v24
    s_nop 0
    v_cvt_pk_bf16_f32 v27, v25, v26
    v_cvt_pk_bf16_f32 v28, -v26, v25
    v_accvgpr_write_b32 a77, v27
    v_accvgpr_write_b32 a93, v28
    v_add_f32 v24, v24, v21
    v_cos_f32 v25, v24
    v_sin_f32 v26, v24
    s_nop 0
    v_cvt_pk_bf16_f32 v27, v25, v26
    v_cvt_pk_bf16_f32 v28, -v26, v25
    v_accvgpr_write_b32 a78, v27
    v_accvgpr_write_b32 a94, v28
    v_add_f32 v24, v24, v21
    v_cos_f32 v25, v24
    v_sin_f32 v26, v24
    s_nop 0
    v_cvt_pk_bf16_f32 v27, v25, v26
    v_cvt_pk_bf16_f32 v28, -v26, v25
    v_accvgpr_write_b32 a79, v27
    v_accvgpr_write_b32 a95, v28
    v_mul_f32 v21, 0x3d000000, v19
    v_mul_f32 v22, v21, v20
    v_mul_f32 v23, 0x41800000, v21
    v_cos_f32 v25, v22
    v_sin_f32 v26, v22
    s_nop 0
    v_cvt_pk_bf16_f32 v27, v25, v26
    v_cvt_pk_bf16_f32 v128, -v26, v25
    v_accvgpr_write_b32 a96, v27
    v_mov_b32 v136, v128
    v_accvgpr_write_b32 a104, v27
    v_add_f32 v24, v22, v21
    v_cos_f32 v25, v24
    v_sin_f32 v26, v24
    s_nop 0
    v_cvt_pk_bf16_f32 v27, v25, v26
    v_cvt_pk_bf16_f32 v129, -v26, v25
    v_accvgpr_write_b32 a97, v27
    v_xor_b32 v27, 0x80008000, v27
    v_xor_b32 v137, 0x80008000, v129
    v_accvgpr_write_b32 a105, v27
    v_add_f32 v24, v24, v21
    v_cos_f32 v25, v24
    v_sin_f32 v26, v24
    s_nop 0
    v_cvt_pk_bf16_f32 v27, v25, v26
    v_cvt_pk_bf16_f32 v130, -v26, v25
    v_accvgpr_write_b32 a98, v27
    v_mov_b32 v138, v130
    v_accvgpr_write_b32 a106, v27
    v_add_f32 v24, v24, v21
    v_cos_f32 v25, v24
    v_sin_f32 v26, v24
    s_nop 0
    v_cvt_pk_bf16_f32 v27, v25, v26
    v_cvt_pk_bf16_f32 v131, -v26, v25
    v_accvgpr_write_b32 a99, v27
    v_xor_b32 v27, 0x80008000, v27
    v_xor_b32 v139, 0x80008000, v131
    v_accvgpr_write_b32 a107, v27
    v_add_f32 v22, v22, v23
    v_cos_f32 v25, v22
    v_sin_f32 v26, v22
    s_nop 0
    v_cvt_pk_bf16_f32 v27, v25, v26
    v_cvt_pk_bf16_f32 v132, -v26, v25
    v_accvgpr_write_b32 a100, v27
    v_mov_b32 v140, v132
    v_accvgpr_write_b32 a108, v27
    v_add_f32 v24, v22, v21
    v_cos_f32 v25, v24
    v_sin_f32 v26, v24
    s_nop 0
    v_cvt_pk_bf16_f32 v27, v25, v26
    v_cvt_pk_bf16_f32 v133, -v26, v25
    v_accvgpr_write_b32 a101, v27
    v_xor_b32 v27, 0x80008000, v27
    v_xor_b32 v141, 0x80008000, v133
    v_accvgpr_write_b32 a109, v27
    v_add_f32 v24, v24, v21
    v_cos_f32 v25, v24
    v_sin_f32 v26, v24
    s_nop 0
    v_cvt_pk_bf16_f32 v27, v25, v26
    v_cvt_pk_bf16_f32 v134, -v26, v25
    v_accvgpr_write_b32 a102, v27
    v_mov_b32 v142, v134
    v_accvgpr_write_b32 a110, v27
    v_add_f32 v24, v24, v21
    v_cos_f32 v25, v24
    v_sin_f32 v26, v24
    s_nop 0
    v_cvt_pk_bf16_f32 v27, v25, v26
    v_cvt_pk_bf16_f32 v135, -v26, v25
    v_accvgpr_write_b32 a103, v27
    v_xor_b32 v27, 0x80008000, v27
    v_xor_b32 v143, 0x80008000, v135
    v_accvgpr_write_b32 a111, v27
    v_mul_f32 v21, 0x3a000000, v18
    v_mul_f32 v22, v21, v20
    v_mul_f32 v23, 0x41800000, v21
    v_cos_f32 v64, v22
    v_sin_f32 v72, -v22
    v_add_f32 v24, v22, v21
    v_cos_f32 v65, v24
    v_sin_f32 v73, -v24
    v_add_f32 v24, v24, v21
    v_cos_f32 v66, v24
    v_sin_f32 v74, -v24
    v_add_f32 v24, v24, v21
    v_cos_f32 v67, v24
    v_sin_f32 v75, -v24
    v_add_f32 v22, v22, v23
    v_cos_f32 v68, v22
    v_sin_f32 v76, -v22
    v_add_f32 v24, v22, v21
    v_cos_f32 v69, v24
    v_sin_f32 v77, -v24
    v_add_f32 v24, v24, v21
    v_cos_f32 v70, v24
    v_sin_f32 v78, -v24
    v_add_f32 v24, v24, v21
    v_cos_f32 v71, v24
    v_sin_f32 v79, -v24
    v_lshlrev_b32 v22, 4, v2
    v_cvt_f32_u32 v22, v22
    v_add_f32 v22, v22, v20
    v_mul_f32 v21, 0x3a000000, v19
    v_mul_f32 v24, v21, v22
    v_cos_f32 v80, v24
    v_sin_f32 v88, -v24
    v_add_f32 v24, v24, v21
    v_cos_f32 v81, v24
    v_sin_f32 v89, -v24
    v_add_f32 v24, v24, v21
    v_cos_f32 v82, v24
    v_sin_f32 v90, -v24
    v_add_f32 v24, v24, v21
    v_cos_f32 v83, v24
    v_sin_f32 v91, -v24
    v_add_f32 v21, 0x3c000000, v21
    v_mul_f32 v24, v21, v22
    v_cos_f32 v84, v24
    v_sin_f32 v92, -v24
    v_add_f32 v24, v24, v21
    v_cos_f32 v85, v24
    v_sin_f32 v93, -v24
    v_add_f32 v24, v24, v21
    v_cos_f32 v86, v24
    v_sin_f32 v94, -v24
    v_add_f32 v24, v24, v21
    v_cos_f32 v87, v24
    v_sin_f32 v95, -v24
    v_and_b32 v16, 3, v12
    v_lshrrev_b32 v3, 2, v12
    v_lshl_add_u32 v4, v16, 3, v3
    v_bfe_u32 v17, v12, 3, 1
    v_lshl_add_u32 v17, v17, 2, v16
    v_xor_b32 v17, v17, v14
    v_lshlrev_b32 v17, 4, v17
    v_lshl_add_u32 v96, v4, 7, v17
    v_add_u32 v96, s48, v96
    v_xor_b32 v97, 32, v96
    v_xor_b32 v98, 64, v96
    v_xor_b32 v99, 96, v96
    v_bfe_u32 v16, v1, 2, 2
    v_lshl_add_u32 v3, v14, 3, v16
    v_lshlrev_b32 v3, 7, v3
    v_lshrrev_b32 v4, 1, v16
    v_lshlrev_b32 v4, 6, v4
    v_bfe_u32 v16, v1, 4, 1
    v_lshlrev_b32 v16, 5, v16
    v_add3_u32 v100, v3, v4, v16
    v_and_b32 v16, 3, v1
    v_lshl_add_u32 v100, v16, 3, v100
    v_add_u32 v100, 114688, v100
    v_xor_b32 v101, 64, v100
    v_mov_b32 v105, 0
    v_mov_b32 v106, 0
    v_mov_b32 v107, 0
    v_mov_b32 v109, 0
    v_mov_b32 v110, 0
    v_mov_b32 v111, 0
    v_mov_b32 v113, 0
    v_mov_b32 v114, 0
    v_mov_b32 v115, 0
    v_cmp_eq_u32 vcc, 0, v14
    v_mov_b32 v3, 0x3f80
    s_nop 0
    v_cndmask_b32 v112, 0, v3, vcc
    v_mov_b32 v116, 0xc0135761
    v_mov_b32 v117, 0xc0135761
    v_mov_b32 v118, 0xbdd2d3e8
    v_mov_b32 v119, 0xbdd2d3e8
    s_lshl_b32 s53, s43, 2
    s_add_u32 s53, s53, s40
    s_mul_i32 s58, s53, 114688
    s_lshl_b32 s55, s44, 13
    s_add_u32 s58, s58, s55
    v_and_b32 v6, 7, v1
    v_bfe_u32 v3, v1, 4, 1
    v_lshlrev_b32 v3, 2, v3
    v_xor_b32 v6, v6, v3
    v_lshlrev_b32 v6, 4, v6
    v_lshrrev_b32 v3, 3, v1
    v_mul_u32_u24 v3, 896, v3
    v_add_u32 v6, v6, v3
    v_add_u32 v7, 6144, v6
    v_add_u32 v8, 12288, v6
    v_add_u32 v9, 18432, v6
    s_and_b32 s95, s41, 1
    s_mul_i32 s95, s95, 56
    s_mul_i32 s88, s40, 14
    s_add_u32 s88, s88, s95
    s_add_u32 s89, s88, 2
    s_add_u32 s90, s88, 4
    s_add_u32 s91, s88, 6
    s_add_u32 s92, s88, 8
    s_add_u32 s93, s88, 10
    s_add_u32 s94, s88, 12
    s_lshl_b32 s47, s15, 7
    s_mul_i32 s52, s41, 28
    s_add_u32 s52, s52, s42
    s_add_u32 s52, s52, 1
    s_min_u32 s52, s52, 223
    s_lshl_b32 s56, s52, 13
    s_add_u32 s57, s56, 4096
    s_add_u32 s54, s56, s49
    s_lshr_b32 s45, s52, 4
    s_lshl_b32 s45, s45, 14
    s_add_u32 s45, s45, s49
    s_add_u32 s45, s45, 8192
    s_add_u32 s46, s48, 114688
    s_mul_i32 s101, s40, 12288
    s_waitcnt lgkmcnt(0)
    s_mul_i32 s14, s14, 0x9e3779b1
    s_add_u32 s14, s14, 0x7f4a7c15
    v_mov_b32 v13, s14
    s_waitcnt vmcnt(0)
    v_mfma_f32_32x32x16_bf16 v[32:47], v[104:107], v[112:115], 0
    v_mfma_f32_32x32x16_bf16 v[48:63], v[108:111], v[112:115], 0
    s_setprio 1
    s_waitcnt lgkmcnt(0)
    s_barrier
    ds_read_b128 a[0:3], v96 offset:0
    ds_read_b64_tr_b16 a[4:5], v100 offset:0
    ds_read_b64_tr_b16 a[6:7], v100 offset:512
    ds_read_b64_tr_b16 a[8:9], v101 offset:0
    ds_read_b64_tr_b16 a[10:11], v101 offset:512
    ds_read_b128 a[12:15], v97 offset:0
    ds_read_b64_tr_b16 a[16:17], v100 offset:2048
    ds_read_b64_tr_b16 a[18:19], v100 offset:2560
    ds_read_b64_tr_b16 a[20:21], v101 offset:2048
    ds_read_b64_tr_b16 a[22:23], v101 offset:2560
    ds_read_b128 a[24:27], v98 offset:0
    ds_read_b64_tr_b16 a[28:29], v100 offset:4096
    ds_read_b64_tr_b16 a[30:31], v100 offset:4608
    ds_read_b64_tr_b16 a[32:33], v101 offset:4096
    ds_read_b64_tr_b16 a[34:35], v101 offset:4608
    s_waitcnt lgkmcnt(10)
    v_mfma_f32_32x32x16_bf16 v[32:47], a[4:7], a[0:3], v[32:47]
    ds_read_b128 a[36:39], v99 offset:0
    ds_read_b64_tr_b16 a[40:41], v100 offset:6144
    ds_read_b64_tr_b16 a[42:43], v100 offset:6656
    v_mfma_f32_32x32x16_bf16 v[48:63], a[8:11], a[0:3], v[48:63]
    ds_read_b64_tr_b16 a[44:45], v101 offset:6144
    ds_read_b64_tr_b16 a[46:47], v101 offset:6656
    s_waitcnt lgkmcnt(10)
    v_mfma_f32_32x32x16_bf16 v[32:47], a[16:19], a[12:15], v[32:47]
    ds_read_b128 a[48:51], v96 offset:16384
    ds_read_b64_tr_b16 a[52:53], v100 offset:8192
    ds_read_b64_tr_b16 a[54:55], v100 offset:8704
    v_mfma_f32_32x32x16_bf16 v[48:63], a[20:23], a[12:15], v[48:63]
    ds_read_b64_tr_b16 a[56:57], v101 offset:8192
    ds_read_b64_tr_b16 a[58:59], v101 offset:8704
    s_waitcnt lgkmcnt(10)
    v_mfma_f32_32x32x16_bf16 v[32:47], a[28:31], a[24:27], v[32:47]
    ds_read_b128 a[0:3], v97 offset:16384
    ds_read_b64_tr_b16 a[4:5], v100 offset:10240
    ds_read_b64_tr_b16 a[6:7], v100 offset:10752
    v_mfma_f32_32x32x16_bf16 v[48:63], a[32:35], a[24:27], v[48:63]
    ds_read_b64_tr_b16 a[8:9], v101 offset:10240
    ds_read_b64_tr_b16 a[10:11], v101 offset:10752
    s_waitcnt lgkmcnt(10)
    v_mfma_f32_32x32x16_bf16 v[32:47], a[40:43], a[36:39], v[32:47]
    ds_read_b128 a[12:15], v98 offset:16384
    ds_read_b64_tr_b16 a[16:17], v100 offset:12288
    ds_read_b64_tr_b16 a[18:19], v100 offset:12800
    v_mfma_f32_32x32x16_bf16 v[48:63], a[44:47], a[36:39], v[48:63]
    ds_read_b64_tr_b16 a[20:21], v101 offset:12288
    ds_read_b64_tr_b16 a[22:23], v101 offset:12800
    s_waitcnt lgkmcnt(10)
    v_mfma_f32_32x32x16_bf16 v[32:47], a[52:55], a[48:51], v[32:47]
    ds_read_b128 a[24:27], v99 offset:16384
    ds_read_b64_tr_b16 a[28:29], v100 offset:14336
    ds_read_b64_tr_b16 a[30:31], v100 offset:14848
    v_mfma_f32_32x32x16_bf16 v[48:63], a[56:59], a[48:51], v[48:63]
    ds_read_b64_tr_b16 a[32:33], v101 offset:14336
    ds_read_b64_tr_b16 a[34:35], v101 offset:14848
    s_waitcnt lgkmcnt(0)
    s_barrier
    v_mfma_f32_32x32x16_bf16 v[32:47], a[4:7], a[0:3], v[32:47]
    ds_read_b128 a[36:39], v96 offset:32768
    ds_read_b64_tr_b16 a[40:41], v100 offset:16384
    ds_read_b64_tr_b16 a[42:43], v100 offset:16896
    v_mfma_f32_32x32x16_bf16 v[48:63], a[8:11], a[0:3], v[48:63]
    ds_read_b64_tr_b16 a[44:45], v101 offset:16384
    ds_read_b64_tr_b16 a[46:47], v101 offset:16896
    v_mfma_f32_32x32x16_bf16 v[32:47], a[16:19], a[12:15], v[32:47]
    ds_read_b128 a[48:51], v97 offset:32768
    ds_read_b64_tr_b16 a[52:53], v100 offset:18432
    ds_read_b64_tr_b16 a[54:55], v100 offset:18944
    v_mfma_f32_32x32x16_bf16 v[48:63], a[20:23], a[12:15], v[48:63]
    ds_read_b64_tr_b16 a[56:57], v101 offset:18432
    ds_read_b64_tr_b16 a[58:59], v101 offset:18944
    v_mfma_f32_32x32x16_bf16 v[32:47], a[28:31], a[24:27], v[32:47]
    ds_read_b128 a[0:3], v98 offset:32768
    ds_read_b64_tr_b16 a[4:5], v100 offset:20480
    ds_read_b64_tr_b16 a[6:7], v100 offset:20992
    v_mfma_f32_32x32x16_bf16 v[48:63], a[32:35], a[24:27], v[48:63]
    ds_read_b64_tr_b16 a[8:9], v101 offset:20480
    ds_read_b64_tr_b16 a[10:11], v101 offset:20992
    s_waitcnt lgkmcnt(10)
    v_mfma_f32_32x32x16_bf16 v[32:47], a[40:43], a[36:39], v[32:47]
    ds_read_b128 a[12:15], v99 offset:32768
    ds_read_b64_tr_b16 a[16:17], v100 offset:22528
    ds_read_b64_tr_b16 a[18:19], v100 offset:23040
    v_mfma_f32_32x32x16_bf16 v[48:63], a[44:47], a[36:39], v[48:63]
    ds_read_b64_tr_b16 a[20:21], v101 offset:22528
    ds_read_b64_tr_b16 a[22:23], v101 offset:23040
    s_waitcnt lgkmcnt(10)
    v_mfma_f32_32x32x16_bf16 v[32:47], a[52:55], a[48:51], v[32:47]
    ds_read_b128 a[24:27], v96 offset:49152
    ds_read_b64_tr_b16 a[28:29], v100 offset:24576
    ds_read_b64_tr_b16 a[30:31], v100 offset:25088
    v_mfma_f32_32x32x16_bf16 v[48:63], a[56:59], a[48:51], v[48:63]
    ds_read_b64_tr_b16 a[32:33], v101 offset:24576
    ds_read_b64_tr_b16 a[34:35], v101 offset:25088
    s_waitcnt lgkmcnt(10)
    v_mfma_f32_32x32x16_bf16 v[32:47], a[4:7], a[0:3], v[32:47]
    ds_read_b128 a[36:39], v97 offset:49152
    ds_read_b64_tr_b16 a[40:41], v100 offset:26624
    ds_read_b64_tr_b16 a[42:43], v100 offset:27136
    v_mfma_f32_32x32x16_bf16 v[48:63], a[8:11], a[0:3], v[48:63]
    ds_read_b64_tr_b16 a[44:45], v101 offset:26624
    ds_read_b64_tr_b16 a[46:47], v101 offset:27136
    s_waitcnt lgkmcnt(10)
    v_mfma_f32_32x32x16_bf16 v[32:47], a[16:19], a[12:15], v[32:47]
    ds_read_b128 a[48:51], v98 offset:49152
    ds_read_b64_tr_b16 a[52:53], v100 offset:28672
    ds_read_b64_tr_b16 a[54:55], v100 offset:29184
    v_mfma_f32_32x32x16_bf16 v[48:63], a[20:23], a[12:15], v[48:63]
    ds_read_b64_tr_b16 a[56:57], v101 offset:28672
    ds_read_b64_tr_b16 a[58:59], v101 offset:29184
    s_waitcnt lgkmcnt(10)
    v_mfma_f32_32x32x16_bf16 v[32:47], a[28:31], a[24:27], v[32:47]
    ds_read_b128 a[0:3], v99 offset:49152
    ds_read_b64_tr_b16 a[4:5], v100 offset:30720
    ds_read_b64_tr_b16 a[6:7], v100 offset:31232
    v_mfma_f32_32x32x16_bf16 v[48:63], a[32:35], a[24:27], v[48:63]
    ds_read_b64_tr_b16 a[8:9], v101 offset:30720
    ds_read_b64_tr_b16 a[10:11], v101 offset:31232
    s_waitcnt lgkmcnt(0)
    s_barrier
    v_lshlrev_b32 v126, 2, v12
    s_lshl_b32 s59, s53, 7
    s_lshl_b32 s95, s44, 14
    s_add_u32 s59, s59, s95
    buffer_load_dword v103, v126, s[76:79], s59 offen sc1
    v_add_u32 v96, 0x10000, v96
    v_add_u32 v97, 0x10000, v97
    v_add_u32 v98, 0x10000, v98
    v_add_u32 v99, 0x10000, v99
    v_mfma_f32_32x32x16_bf16 v[32:47], a[40:43], a[36:39], v[32:47]
    ds_read_b128 a[12:15], v96 offset:0
    ds_read_b64_tr_b16 a[16:17], v100 offset:32768
    ds_read_b64_tr_b16 a[18:19], v100 offset:33280
    v_mfma_f32_32x32x16_bf16 v[48:63], a[44:47], a[36:39], v[48:63]
    ds_read_b64_tr_b16 a[20:21], v101 offset:32768
    ds_read_b64_tr_b16 a[22:23], v101 offset:33280
    v_mfma_f32_32x32x16_bf16 v[32:47], a[52:55], a[48:51], v[32:47]
    ds_read_b128 a[24:27], v97 offset:0
    ds_read_b64_tr_b16 a[28:29], v100 offset:34816
    ds_read_b64_tr_b16 a[30:31], v100 offset:35328
    v_mfma_f32_32x32x16_bf16 v[48:63], a[56:59], a[48:51], v[48:63]
    ds_read_b64_tr_b16 a[32:33], v101 offset:34816
    ds_read_b64_tr_b16 a[34:35], v101 offset:35328
    v_mfma_f32_32x32x16_bf16 v[32:47], a[4:7], a[0:3], v[32:47]
    ds_read_b128 a[36:39], v98 offset:0
    ds_read_b64_tr_b16 a[40:41], v100 offset:36864
    ds_read_b64_tr_b16 a[42:43], v100 offset:37376
    v_mfma_f32_32x32x16_bf16 v[48:63], a[8:11], a[0:3], v[48:63]
    ds_read_b64_tr_b16 a[44:45], v101 offset:36864
    ds_read_b64_tr_b16 a[46:47], v101 offset:37376
    s_waitcnt lgkmcnt(10)
    v_mfma_f32_32x32x16_bf16 v[32:47], a[16:19], a[12:15], v[32:47]
    ds_read_b128 a[48:51], v99 offset:0
    ds_read_b64_tr_b16 a[52:53], v100 offset:38912
    ds_read_b64_tr_b16 a[54:55], v100 offset:39424
    v_mfma_f32_32x32x16_bf16 v[48:63], a[20:23], a[12:15], v[48:63]
    ds_read_b64_tr_b16 a[56:57], v101 offset:38912
    ds_read_b64_tr_b16 a[58:59], v101 offset:39424
    s_waitcnt lgkmcnt(10)
    v_mfma_f32_32x32x16_bf16 v[32:47], a[28:31], a[24:27], v[32:47]
    ds_read_b128 a[0:3], v96 offset:16384
    ds_read_b64_tr_b16 a[4:5], v100 offset:40960
    ds_read_b64_tr_b16 a[6:7], v100 offset:41472
    v_mfma_f32_32x32x16_bf16 v[48:63], a[32:35], a[24:27], v[48:63]
    ds_read_b64_tr_b16 a[8:9], v101 offset:40960
    ds_read_b64_tr_b16 a[10:11], v101 offset:41472
    s_waitcnt lgkmcnt(10)
    v_mfma_f32_32x32x16_bf16 v[32:47], a[40:43], a[36:39], v[32:47]
    ds_read_b128 a[12:15], v97 offset:16384
    ds_read_b64_tr_b16 a[16:17], v100 offset:43008
    ds_read_b64_tr_b16 a[18:19], v100 offset:43520
    v_mfma_f32_32x32x16_bf16 v[48:63], a[44:47], a[36:39], v[48:63]
    ds_read_b64_tr_b16 a[20:21], v101 offset:43008
    ds_read_b64_tr_b16 a[22:23], v101 offset:43520
    s_waitcnt lgkmcnt(10)
    v_mfma_f32_32x32x16_bf16 v[32:47], a[52:55], a[48:51], v[32:47]
    ds_read_b128 a[24:27], v98 offset:16384
    ds_read_b64_tr_b16 a[28:29], v100 offset:45056
    ds_read_b64_tr_b16 a[30:31], v100 offset:45568
    v_mfma_f32_32x32x16_bf16 v[48:63], a[56:59], a[48:51], v[48:63]
    ds_read_b64_tr_b16 a[32:33], v101 offset:45056
    ds_read_b64_tr_b16 a[34:35], v101 offset:45568
    s_waitcnt lgkmcnt(10)
    v_mfma_f32_32x32x16_bf16 v[32:47], a[4:7], a[0:3], v[32:47]
    ds_read_b128 a[36:39], v99 offset:16384
    ds_read_b64_tr_b16 a[40:41], v100 offset:47104
    ds_read_b64_tr_b16 a[42:43], v100 offset:47616
    v_mfma_f32_32x32x16_bf16 v[48:63], a[8:11], a[0:3], v[48:63]
    ds_read_b64_tr_b16 a[44:45], v101 offset:47104
    ds_read_b64_tr_b16 a[46:47], v101 offset:47616
    s_waitcnt lgkmcnt(0)
    s_barrier
    v_mfma_f32_32x32x16_bf16 v[32:47], a[16:19], a[12:15], v[32:47]
    ds_read_b128 a[48:51], v96 offset:32768
    ds_read_b64_tr_b16 a[52:53], v100 offset:0
    ds_read_b64_tr_b16 a[54:55], v100 offset:512
    v_mfma_f32_32x32x16_bf16 v[48:63], a[20:23], a[12:15], v[48:63]
    ds_read_b64_tr_b16 a[56:57], v101 offset:0
    ds_read_b64_tr_b16 a[58:59], v101 offset:512
    v_mfma_f32_32x32x16_bf16 v[32:47], a[28:31], a[24:27], v[32:47]
    ds_read_b128 a[0:3], v97 offset:32768
    ds_read_b64_tr_b16 a[4:5], v100 offset:2048
    ds_read_b64_tr_b16 a[6:7], v100 offset:2560
    v_mfma_f32_32x32x16_bf16 v[48:63], a[32:35], a[24:27], v[48:63]
    ds_read_b64_tr_b16 a[8:9], v101 offset:2048
    ds_read_b64_tr_b16 a[10:11], v101 offset:2560
    v_mfma_f32_32x32x16_bf16 v[32:47], a[40:43], a[36:39], v[32:47]
    ds_read_b128 a[12:15], v98 offset:32768
    ds_read_b64_tr_b16 a[16:17], v100 offset:4096
    ds_read_b64_tr_b16 a[18:19], v100 offset:4608
    v_mfma_f32_32x32x16_bf16 v[48:63], a[44:47], a[36:39], v[48:63]
    ds_read_b64_tr_b16 a[20:21], v101 offset:4096
    ds_read_b64_tr_b16 a[22:23], v101 offset:4608
    s_waitcnt lgkmcnt(10)
    v_mfma_f32_32x32x16_bf16 v[32:47], a[52:55], a[48:51], v[32:47]
    ds_read_b128 a[24:27], v99 offset:32768
    ds_read_b64_tr_b16 a[28:29], v100 offset:6144
    ds_read_b64_tr_b16 a[30:31], v100 offset:6656
    v_mfma_f32_32x32x16_bf16 v[48:63], a[56:59], a[48:51], v[48:63]
    ds_read_b64_tr_b16 a[32:33], v101 offset:6144
    ds_read_b64_tr_b16 a[34:35], v101 offset:6656
    s_waitcnt lgkmcnt(0)
    s_barrier
    v_mfma_f32_32x32x16_bf16 v[32:47], a[4:7], a[0:3], v[32:47]
    v_mfma_f32_32x32x16_bf16 v[48:63], a[8:11], a[0:3], v[48:63]
    v_mfma_f32_32x32x16_bf16 v[32:47], a[16:19], a[12:15], v[32:47]
    v_mfma_f32_32x32x16_bf16 v[48:63], a[20:23], a[12:15], v[48:63]
    v_mfma_f32_32x32x16_bf16 v[32:47], a[28:31], a[24:27], v[32:47]
    v_mfma_f32_32x32x16_bf16 v[48:63], a[32:35], a[24:27], v[48:63]
    s_setprio 0
    s_waitcnt vmcnt(0)
    v_mov_b32 v114, v103
    s_lshr_b32 s59, s52, 4
    s_lshl_b32 s59, s59, 11
    s_add_u32 s59, s59, 524288
    v_lshlrev_b32 v96, 7, v1
    v_add_u32 v96, s59, v96
    v_and_b32 v97, 7, v1
    v_lshl_add_u32 v97, v2, 3, v97
    v_lshlrev_b32 v97, 7, v97
    v_add_u32 v97, 32768, v97
    v_cmp_gt_u32 vcc, 16, v1
    s_nop 1
    v_cndmask_b32 v96, v97, v96, vcc
    buffer_load_dword v97, v96, s[36:39], 0 offen sc1
    v_mul_f32 v100, v32, v32
    v_mul_f32 v102, v34, v34
    v_mul_f32 v101, v33, v33
    v_mul_f32 v103, v35, v35
    v_fma_f32 v100, v100, v118, v116
    v_fma_f32 v102, v102, v118, v116
    v_fma_f32 v101, v101, v118, v116
    v_fma_f32 v103, v103, v118, v116
    v_mul_f32 v100, v32, v100
    v_mul_f32 v102, v34, v102
    v_mul_f32 v101, v33, v101
    v_mul_f32 v103, v35, v103
    v_exp_f32 v100, v100
    v_exp_f32 v102, v102
    v_exp_f32 v101, v101
    v_exp_f32 v103, v103
    v_fma_f32 v100, v100, v114, v114
    v_fma_f32 v102, v102, v114, v114
    v_fma_f32 v101, v101, v114, v114
    v_fma_f32 v103, v103, v114, v114
    v_rcp_f32 v100, v100
    v_rcp_f32 v102, v102
    v_rcp_f32 v101, v101
    v_rcp_f32 v103, v103
    v_mul_f32 v100, v32, v100
    v_mul_f32 v102, v34, v102
    v_mul_f32 v101, v33, v101
    v_mul_f32 v103, v35, v103
    v_cvt_pk_bf16_f32 v16, v100, v101
    v_cvt_pk_bf16_f32 v17, v102, v103
    v_mul_f32 v100, v36, v36
    v_mul_f32 v102, v38, v38
    v_mul_f32 v101, v37, v37
    v_mul_f32 v103, v39, v39
    v_fma_f32 v100, v100, v118, v116
    v_fma_f32 v102, v102, v118, v116
    v_fma_f32 v101, v101, v118, v116
    v_fma_f32 v103, v103, v118, v116
    v_mul_f32 v100, v36, v100
    v_mul_f32 v102, v38, v102
    v_mul_f32 v101, v37, v101
    v_mul_f32 v103, v39, v103
    v_exp_f32 v100, v100
    v_exp_f32 v102, v102
    v_exp_f32 v101, v101
    v_exp_f32 v103, v103
    v_fma_f32 v100, v100, v114, v114
    v_fma_f32 v102, v102, v114, v114
    v_fma_f32 v101, v101, v114, v114
    v_fma_f32 v103, v103, v114, v114
    v_rcp_f32 v100, v100
    v_rcp_f32 v102, v102
    v_rcp_f32 v101, v101
    v_rcp_f32 v103, v103
    v_mul_f32 v100, v36, v100
    v_mul_f32 v102, v38, v102
    v_mul_f32 v101, v37, v101
    v_mul_f32 v103, v39, v103
    v_cvt_pk_bf16_f32 v18, v100, v101
    v_cvt_pk_bf16_f32 v19, v102, v103
    buffer_store_dwordx4 v[16:19], v10, s[28:31], s58 offen offset:0 sc1
    s_barrier
    v_mul_f32 v100, v40, v40
    v_mul_f32 v102, v42, v42
    v_mul_f32 v101, v41, v41
    v_mul_f32 v103, v43, v43
    v_fma_f32 v100, v100, v118, v116
    v_fma_f32 v102, v102, v118, v116
    v_fma_f32 v101, v101, v118, v116
    v_fma_f32 v103, v103, v118, v116
    v_mul_f32 v100, v40, v100
    v_mul_f32 v102, v42, v102
    v_mul_f32 v101, v41, v101
    v_mul_f32 v103, v43, v103
    v_exp_f32 v100, v100
    v_exp_f32 v102, v102
    v_exp_f32 v101, v101
    v_exp_f32 v103, v103
    v_fma_f32 v100, v100, v114, v114
    v_fma_f32 v102, v102, v114, v114
    v_fma_f32 v101, v101, v114, v114
    v_fma_f32 v103, v103, v114, v114
    v_rcp_f32 v100, v100
    v_rcp_f32 v102, v102
    v_rcp_f32 v101, v101
    v_rcp_f32 v103, v103
    v_mul_f32 v100, v40, v100
    v_mul_f32 v102, v42, v102
    v_mul_f32 v101, v41, v101
    v_mul_f32 v103, v43, v103
    v_cvt_pk_bf16_f32 v20, v100, v101
    v_cvt_pk_bf16_f32 v21, v102, v103
    v_mul_f32 v100, v44, v44
    v_mul_f32 v102, v46, v46
    v_mul_f32 v101, v45, v45
    v_mul_f32 v103, v47, v47
    v_fma_f32 v100, v100, v118, v116
    v_fma_f32 v102, v102, v118, v116
    v_fma_f32 v101, v101, v118, v116
    v_fma_f32 v103, v103, v118, v116
    v_mul_f32 v100, v44, v100
    v_mul_f32 v102, v46, v102
    v_mul_f32 v101, v45, v101
    v_mul_f32 v103, v47, v103
    v_exp_f32 v100, v100
    v_exp_f32 v102, v102
    v_exp_f32 v101, v101
    v_exp_f32 v103, v103
    v_fma_f32 v100, v100, v114, v114
    v_fma_f32 v102, v102, v114, v114
    v_fma_f32 v101, v101, v114, v114
    v_fma_f32 v103, v103, v114, v114
    v_rcp_f32 v100, v100
    v_rcp_f32 v102, v102
    v_rcp_f32 v101, v101
    v_rcp_f32 v103, v103
    v_mul_f32 v100, v44, v100
    v_mul_f32 v102, v46, v102
    v_mul_f32 v101, v45, v101
    v_mul_f32 v103, v47, v103
    v_cvt_pk_bf16_f32 v22, v100, v101
    v_cvt_pk_bf16_f32 v23, v102, v103
    buffer_store_dwordx4 v[20:23], v10, s[28:31], s58 offen offset:1024 sc1
    s_waitcnt vmcnt(2)
    s_mov_b32 s97, 0
POLL3:
    v_cmp_ne_u32 s[84:85], s14, v97
    s_nop 0
    s_cmp_lg_u64 s[84:85], 0
    s_cbranch_scc0 POLLOK3
    s_sleep 4
    s_add_u32 s97, s97, 1
    s_cmp_gt_u32 s97, 0x40000
    s_cbranch_scc1 K_END
    buffer_load_dword v97, v96, s[36:39], 0 offen sc1
    s_waitcnt vmcnt(0)
    s_branch POLL3
POLLOK3:
    v_mul_f32 v100, v48, v48
    v_mul_f32 v102, v50, v50
    v_mul_f32 v101, v49, v49
    v_mul_f32 v103, v51, v51
    v_fma_f32 v100, v100, v118, v116
    v_fma_f32 v102, v102, v118, v116
    v_fma_f32 v101, v101, v118, v116
    buffer_load_dwordx4 a[0:3], v15, s[32:35], s56 offen offset:0 sc1
    v_fma_f32 v103, v103, v118, v116
    v_mul_f32 v100, v48, v100
    v_mul_f32 v102, v50, v102
    v_mul_f32 v101, v49, v101
    v_mul_f32 v103, v51, v103
    v_exp_f32 v100, v100
    v_exp_f32 v102, v102
    buffer_load_dwordx4 a[16:19], v15, s[32:35], s56 offen offset:256 sc1
    v_exp_f32 v101, v101
    v_exp_f32 v103, v103
    v_fma_f32 v100, v100, v114, v114
    v_fma_f32 v102, v102, v114, v114
    v_fma_f32 v101, v101, v114, v114
    v_fma_f32 v103, v103, v114, v114
    v_rcp_f32 v100, v100
    buffer_load_dwordx4 a[4:7], v15, s[32:35], s56 offen offset:2048 sc1
    v_rcp_f32 v102, v102
    v_rcp_f32 v101, v101
    v_rcp_f32 v103, v103
    v_mul_f32 v100, v48, v100
    v_mul_f32 v102, v50, v102
    v_mul_f32 v101, v49, v101
    v_mul_f32 v103, v51, v103
    buffer_load_dwordx4 a[20:23], v15, s[32:35], s56 offen offset:2304 sc1
    v_cvt_pk_bf16_f32 v24, v100, v101
    v_cvt_pk_bf16_f32 v25, v102, v103
    v_mul_f32 v100, v52, v52
    v_mul_f32 v102, v54, v54
    v_mul_f32 v101, v53, v53
    v_mul_f32 v103, v55, v55
    buffer_load_dwordx4 a[8:11], v15, s[32:35], s57 offen offset:0 sc1
    v_fma_f32 v100, v100, v118, v116
    v_fma_f32 v102, v102, v118, v116
    v_fma_f32 v101, v101, v118, v116
    v_fma_f32 v103, v103, v118, v116
    v_mul_f32 v100, v52, v100
    v_mul_f32 v102, v54, v102
    v_mul_f32 v101, v53, v101
    buffer_load_dwordx4 a[24:27], v15, s[32:35], s57 offen offset:256 sc1
    v_mul_f32 v103, v55, v103
    v_exp_f32 v100, v100
    v_exp_f32 v102, v102
    v_exp_f32 v101, v101
    v_exp_f32 v103, v103
    v_fma_f32 v100, v100, v114, v114
    v_fma_f32 v102, v102, v114, v114
    buffer_load_dwordx4 a[12:15], v15, s[32:35], s57 offen offset:2048 sc1
    v_fma_f32 v101, v101, v114, v114
    v_fma_f32 v103, v103, v114, v114
    v_rcp_f32 v100, v100
    v_rcp_f32 v102, v102
    v_rcp_f32 v101, v101
    v_rcp_f32 v103, v103
    v_mul_f32 v100, v52, v100
    buffer_load_dwordx4 a[28:31], v15, s[32:35], s57 offen offset:2304 sc1
    v_mul_f32 v102, v54, v102
    v_mul_f32 v101, v53, v101
    v_mul_f32 v103, v55, v103
    v_cvt_pk_bf16_f32 v26, v100, v101
    v_cvt_pk_bf16_f32 v27, v102, v103
    buffer_store_dwordx4 v[24:27], v10, s[28:31], s58 offen offset:2048 sc1
    buffer_load_dwordx4 v[120:123], v10, s[72:75], s54 offen offset:0 sc1
    v_mul_f32 v100, v56, v56
    v_mul_f32 v102, v58, v58
    v_mul_f32 v101, v57, v57
    v_mul_f32 v103, v59, v59
    v_fma_f32 v100, v100, v118, v116
    v_fma_f32 v102, v102, v118, v116
    v_fma_f32 v101, v101, v118, v116
    buffer_load_dwordx4 v[124:127], v10, s[72:75], s54 offen offset:1024 sc1
    v_fma_f32 v103, v103, v118, v116
    v_mul_f32 v100, v56, v100
    v_mul_f32 v102, v58, v102
    v_mul_f32 v101, v57, v101
    v_mul_f32 v103, v59, v103
    v_exp_f32 v100, v100
    v_exp_f32 v102, v102
    buffer_load_dwordx4 v[104:107], v15, s[76:79], s45 offen offset:0 sc1
    v_exp_f32 v101, v101
    v_exp_f32 v103, v103
    v_fma_f32 v100, v100, v114, v114
    v_fma_f32 v102, v102, v114, v114
    v_fma_f32 v101, v101, v114, v114
    v_fma_f32 v103, v103, v114, v114
    v_rcp_f32 v100, v100
    buffer_load_dwordx4 v[108:111], v15, s[76:79], s45 offen offset:256 sc1
    v_rcp_f32 v102, v102
    v_rcp_f32 v101, v101
    v_rcp_f32 v103, v103
    v_mul_f32 v100, v56, v100
    v_mul_f32 v102, v58, v102
    v_mul_f32 v101, v57, v101
    v_mul_f32 v103, v59, v103
    v_cvt_pk_bf16_f32 v28, v100, v101
    v_cvt_pk_bf16_f32 v29, v102, v103
    v_mul_f32 v100, v60, v60
    v_mul_f32 v102, v62, v62
    v_mul_f32 v101, v61, v61
    v_mul_f32 v103, v63, v63
    v_fma_f32 v100, v100, v118, v116
    v_fma_f32 v102, v102, v118, v116
    v_fma_f32 v101, v101, v118, v116
    v_fma_f32 v103, v103, v118, v116
    v_mul_f32 v100, v60, v100
    v_mul_f32 v102, v62, v102
    v_mul_f32 v101, v61, v101
    v_mul_f32 v103, v63, v103
    v_exp_f32 v100, v100
    v_exp_f32 v102, v102
    v_exp_f32 v101, v101
    v_exp_f32 v103, v103
    v_fma_f32 v100, v100, v114, v114
    v_fma_f32 v102, v102, v114, v114
    v_fma_f32 v101, v101, v114, v114
    v_fma_f32 v103, v103, v114, v114
    v_rcp_f32 v100, v100
    v_rcp_f32 v102, v102
    v_rcp_f32 v101, v101
    v_rcp_f32 v103, v103
    v_mul_f32 v100, v60, v100
    v_mul_f32 v102, v62, v102
    v_mul_f32 v101, v61, v101
    v_mul_f32 v103, v63, v103
    v_cvt_pk_bf16_f32 v30, v100, v101
    v_cvt_pk_bf16_f32 v31, v102, v103
    buffer_store_dwordx4 v[28:31], v10, s[28:31], s58 offen offset:3072 sc1
    s_setprio 2
    s_waitcnt vmcnt(12)
    v_mfma_f32_16x16x32_bf16 v[16:19], a[0:3], a[64:67], 0
    v_mfma_f32_16x16x32_bf16 v[24:27], a[0:3], a[80:83], 0
    v_mfma_f32_16x16x32_bf16 v[20:23], a[16:19], a[64:67], 0
    v_mfma_f32_16x16x32_bf16 v[28:31], a[16:19], a[80:83], 0
    s_waitcnt vmcnt(10)
    v_mfma_f32_16x16x32_bf16 v[16:19], a[4:7], a[68:71], v[16:19]
    v_mfma_f32_16x16x32_bf16 v[24:27], a[4:7], a[84:87], v[24:27]
    v_mfma_f32_16x16x32_bf16 v[20:23], a[20:23], a[68:71], v[20:23]
    v_mfma_f32_16x16x32_bf16 v[28:31], a[20:23], a[84:87], v[28:31]
    s_waitcnt vmcnt(8)
    v_mfma_f32_16x16x32_bf16 v[16:19], a[8:11], a[72:75], v[16:19]
    v_mfma_f32_16x16x32_bf16 v[24:27], a[8:11], a[88:91], v[24:27]
    v_mfma_f32_16x16x32_bf16 v[20:23], a[24:27], a[72:75], v[20:23]
    v_mfma_f32_16x16x32_bf16 v[28:31], a[24:27], a[88:91], v[28:31]
    s_waitcnt vmcnt(6)
    v_mfma_f32_16x16x32_bf16 v[16:19], a[12:15], a[76:79], v[16:19]
    v_mfma_f32_16x16x32_bf16 v[24:27], a[12:15], a[92:95], v[24:27]
    v_mfma_f32_16x16x32_bf16 v[20:23], a[28:31], a[76:79], v[20:23]
    v_mfma_f32_16x16x32_bf16 v[28:31], a[28:31], a[92:95], v[28:31]
    s_nop 4
    v_pk_mul_f32 v[32:33], v[16:17], v[64:65]
    v_pk_mul_f32 v[40:41], v[16:17], v[72:73]
    v_pk_mul_f32 v[34:35], v[18:19], v[66:67]
    v_pk_mul_f32 v[42:43], v[18:19], v[74:75]
    v_pk_mul_f32 v[36:37], v[20:21], v[68:69]
    v_pk_mul_f32 v[44:45], v[20:21], v[76:77]
    v_pk_mul_f32 v[38:39], v[22:23], v[70:71]
    v_pk_mul_f32 v[46:47], v[22:23], v[78:79]
    v_pk_fma_f32 v[32:33], v[24:25], v[72:73], v[32:33] neg_lo:[1,0,0] neg_hi:[1,0,0]
    v_pk_fma_f32 v[40:41], v[24:25], v[64:65], v[40:41]
    v_pk_fma_f32 v[34:35], v[26:27], v[74:75], v[34:35] neg_lo:[1,0,0] neg_hi:[1,0,0]
    v_pk_fma_f32 v[42:43], v[26:27], v[66:67], v[42:43]
    v_pk_fma_f32 v[36:37], v[28:29], v[76:77], v[36:37] neg_lo:[1,0,0] neg_hi:[1,0,0]
    v_pk_fma_f32 v[44:45], v[28:29], v[68:69], v[44:45]
    v_pk_fma_f32 v[38:39], v[30:31], v[78:79], v[38:39] neg_lo:[1,0,0] neg_hi:[1,0,0]
    v_pk_fma_f32 v[46:47], v[30:31], v[70:71], v[46:47]
    v_cvt_pk_bf16_f32 v48, v32, v40
    v_cvt_pk_bf16_f32 v49, v33, v41
    v_cvt_pk_bf16_f32 v50, v34, v42
    v_cvt_pk_bf16_f32 v51, v35, v43
    v_cvt_pk_bf16_f32 v52, v36, v44
    v_cvt_pk_bf16_f32 v53, v37, v45
    v_cvt_pk_bf16_f32 v54, v38, v46
    v_cvt_pk_bf16_f32 v55, v39, v47
    s_waitcnt vmcnt(3)
    v_mfma_f32_16x16x32_bf16 v[56:59], a[96:99], v[48:51], 0
    v_lshlrev_b32 v64, 16, v120
    v_and_b32 v72, 0xffff0000, v120
    v_mfma_f32_16x16x32_bf16 v[96:99], v[128:131], v[48:51], 0
    v_lshlrev_b32 v65, 16, v121
    v_and_b32 v73, 0xffff0000, v121
    v_mfma_f32_16x16x32_bf16 v[60:63], a[104:107], v[48:51], 0
    v_lshlrev_b32 v66, 16, v122
    v_and_b32 v74, 0xffff0000, v122
    v_mfma_f32_16x16x32_bf16 v[100:103], v[136:139], v[48:51], 0
    v_lshlrev_b32 v67, 16, v123
    v_and_b32 v75, 0xffff0000, v123
    v_mfma_f32_16x16x32_bf16 v[56:59], a[100:103], v[52:55], v[56:59]
    v_lshlrev_b32 v68, 16, v124
    v_and_b32 v76, 0xffff0000, v124
    v_mfma_f32_16x16x32_bf16 v[96:99], v[132:135], v[52:55], v[96:99]
    v_lshlrev_b32 v69, 16, v125
    v_and_b32 v77, 0xffff0000, v125
    v_mfma_f32_16x16x32_bf16 v[60:63], a[108:111], v[52:55], v[60:63]
    v_lshlrev_b32 v70, 16, v126
    v_and_b32 v78, 0xffff0000, v126
    v_mfma_f32_16x16x32_bf16 v[100:103], v[140:143], v[52:55], v[100:103]
    v_lshlrev_b32 v71, 16, v127
    v_and_b32 v79, 0xffff0000, v127
    s_waitcnt vmcnt(0)
    s_lshl_b32 s96, s53, 12
    s_lshl_b32 s95, s44, 8
    s_add_u32 s96, s96, s95
    s_add_u32 s96, s96, 65536
    s_mov_b64 exec, 1
    buffer_store_dword v13, v11, s[36:39], s96 offen sc1
    s_mov_b64 exec, -1
    s_lshr_b32 s43, s41, 1
    s_lshl_b32 s43, s43, 2
    s_add_u32 s43, s43, s3
    s_lshl_b32 s43, s43, 1
    s_and_b32 s95, s41, 1
    s_xor_b32 s95, s95, 1
    s_add_u32 s43, s43, s95
    s_lshr_b32 s95, s40, 1
    s_and_b32 s44, s40, 1
    s_lshl_b32 s53, s43, 1
    s_add_u32 s53, s53, s95
    s_xor_b32 s55, s53, 1
    s_mul_i32 s56, s53, 114688
    s_mul_i32 s57, s55, 114688
    v_and_b32 v112, 3, v1
    v_bfe_u32 v3, v1, 2, 1
    v_lshl_add_u32 v112, v3, 5, v112
    v_lshlrev_b32 v112, 7, v112
    s_lshl_b32 s59, s43, 13
    s_lshr_b32 s95, s88, 2
    s_lshl_b32 s95, s95, 7
    s_add_u32 s59, s59, s95
    s_add_u32 s59, s59, 65536
    v_pk_mul_f32 v[32:33], v[56:57], v[64:65]
    v_pk_mul_f32 v[40:41], v[56:57], v[72:73]
    v_pk_mul_f32 v[34:35], v[58:59], v[66:67]
    v_pk_mul_f32 v[42:43], v[58:59], v[74:75]
    v_pk_mul_f32 v[36:37], v[60:61], v[68:69]
    v_pk_mul_f32 v[44:45], v[60:61], v[76:77]
    v_pk_mul_f32 v[38:39], v[62:63], v[70:71]
    v_pk_mul_f32 v[46:47], v[62:63], v[78:79]
    v_pk_fma_f32 v[32:33], v[96:97], v[72:73], v[32:33] neg_lo:[1,0,0] neg_hi:[1,0,0]
    v_pk_fma_f32 v[40:41], v[96:97], v[64:65], v[40:41]
    v_pk_fma_f32 v[34:35], v[98:99], v[74:75], v[34:35] neg_lo:[1,0,0] neg_hi:[1,0,0]
    v_pk_fma_f32 v[42:43], v[98:99], v[66:67], v[42:43]
    v_pk_fma_f32 v[36:37], v[100:101], v[76:77], v[36:37] neg_lo:[1,0,0] neg_hi:[1,0,0]
    v_pk_fma_f32 v[44:45], v[100:101], v[68:69], v[44:45]
    v_pk_fma_f32 v[38:39], v[102:103], v[78:79], v[38:39] neg_lo:[1,0,0] neg_hi:[1,0,0]
    v_pk_fma_f32 v[46:47], v[102:103], v[70:71], v[46:47]
    v_cvt_pk_bf16_f32 v48, v32, -v40
    v_cvt_pk_bf16_f32 v49, v33, -v41
    v_cvt_pk_bf16_f32 v50, v34, -v42
    v_cvt_pk_bf16_f32 v51, v35, -v43
    v_cvt_pk_bf16_f32 v52, v36, -v44
    v_cvt_pk_bf16_f32 v53, v37, -v45
    v_cvt_pk_bf16_f32 v54, v38, -v46
    v_cvt_pk_bf16_f32 v55, v39, -v47
    v_mfma_f32_16x16x32_bf16 v[16:19], v[48:51], a[96:99], 0
    v_mfma_f32_16x16x32_bf16 v[24:27], v[48:51], v[128:131], 0
    v_mfma_f32_16x16x32_bf16 v[20:23], v[48:51], a[104:107], 0
    v_mfma_f32_16x16x32_bf16 v[28:31], v[48:51], v[136:139], 0
    v_mfma_f32_16x16x32_bf16 v[16:19], v[52:55], a[100:103], v[16:19]
    v_mfma_f32_16x16x32_bf16 v[24:27], v[52:55], v[132:135], v[24:27]
    v_mfma_f32_16x16x32_bf16 v[20:23], v[52:55], a[108:111], v[20:23]
    v_mfma_f32_16x16x32_bf16 v[28:31], v[52:55], v[140:143], v[28:31]
    v_lshlrev_b32 v3, 4, v0
    s_nop 3
    v_pk_mul_f32 v[32:33], v[16:17], v[80:81]
    v_pk_mul_f32 v[40:41], v[16:17], v[88:89]
    v_pk_mul_f32 v[34:35], v[18:19], v[82:83]
    v_pk_mul_f32 v[42:43], v[18:19], v[90:91]
    v_pk_mul_f32 v[36:37], v[20:21], v[84:85]
    v_pk_mul_f32 v[44:45], v[20:21], v[92:93]
    v_pk_mul_f32 v[38:39], v[22:23], v[86:87]
    v_pk_mul_f32 v[46:47], v[22:23], v[94:95]
    v_pk_fma_f32 v[32:33], v[24:25], v[88:89], v[32:33] neg_lo:[1,0,0] neg_hi:[1,0,0]
    v_pk_fma_f32 v[40:41], v[24:25], v[80:81], v[40:41]
    v_pk_fma_f32 v[34:35], v[26:27], v[90:91], v[34:35] neg_lo:[1,0,0] neg_hi:[1,0,0]
    v_pk_fma_f32 v[42:43], v[26:27], v[82:83], v[42:43]
    v_pk_fma_f32 v[36:37], v[28:29], v[92:93], v[36:37] neg_lo:[1,0,0] neg_hi:[1,0,0]
    v_pk_fma_f32 v[44:45], v[28:29], v[84:85], v[44:45]
    v_pk_fma_f32 v[38:39], v[30:31], v[94:95], v[38:39] neg_lo:[1,0,0] neg_hi:[1,0,0]
    v_pk_fma_f32 v[46:47], v[30:31], v[86:87], v[46:47]
    v_cvt_pk_bf16_f32 v48, v32, v40
    v_cvt_pk_bf16_f32 v49, v33, v41
    v_cvt_pk_bf16_f32 v50, v34, v42
    v_cvt_pk_bf16_f32 v51, v35, v43
    v_cvt_pk_bf16_f32 v52, v36, v44
    v_cvt_pk_bf16_f32 v53, v37, v45
    v_cvt_pk_bf16_f32 v54, v38, v46
    v_cvt_pk_bf16_f32 v55, v39, v47
    ds_write_b128 v3, v[48:51] offset:57344
    ds_write_b128 v3, v[52:55] offset:61440
    s_waitcnt lgkmcnt(0)
    s_barrier
    ds_read_b128 a[0:3], v10 offset:57344
    ds_read_b128 a[16:19], v10 offset:61440
    ds_read_b128 a[4:7], v10 offset:58368
    ds_read_b128 a[20:23], v10 offset:62464
    ds_read_b128 a[8:11], v10 offset:59392
    ds_read_b128 a[24:27], v10 offset:63488
    ds_read_b128 a[12:15], v10 offset:60416
    ds_read_b128 a[28:31], v10 offset:64512
    s_waitcnt lgkmcnt(6)
    v_mfma_f32_16x16x32_bf16 v[56:59], a[64:67], a[0:3], 0
    v_mfma_f32_16x16x32_bf16 v[96:99], a[80:83], a[0:3], 0
    v_mfma_f32_16x16x32_bf16 v[60:63], a[64:67], a[16:19], 0
    v_mfma_f32_16x16x32_bf16 v[100:103], a[80:83], a[16:19], 0
    s_waitcnt lgkmcnt(4)
    v_mfma_f32_16x16x32_bf16 v[56:59], a[68:71], a[4:7], v[56:59]
    v_mfma_f32_16x16x32_bf16 v[96:99], a[84:87], a[4:7], v[96:99]
    v_mfma_f32_16x16x32_bf16 v[60:63], a[68:71], a[20:23], v[60:63]
    v_mfma_f32_16x16x32_bf16 v[100:103], a[84:87], a[20:23], v[100:103]
    s_waitcnt lgkmcnt(2)
    v_mfma_f32_16x16x32_bf16 v[56:59], a[72:75], a[8:11], v[56:59]
    v_mfma_f32_16x16x32_bf16 v[96:99], a[88:91], a[8:11], v[96:99]
    v_mfma_f32_16x16x32_bf16 v[60:63], a[72:75], a[24:27], v[60:63]
    v_mfma_f32_16x16x32_bf16 v[100:103], a[88:91], a[24:27], v[100:103]
    s_waitcnt lgkmcnt(0)
    v_mfma_f32_16x16x32_bf16 v[56:59], a[76:79], a[12:15], v[56:59]
    v_mfma_f32_16x16x32_bf16 v[96:99], a[92:95], a[12:15], v[96:99]
    v_mfma_f32_16x16x32_bf16 v[60:63], a[76:79], a[28:31], v[60:63]
    v_mfma_f32_16x16x32_bf16 v[100:103], a[92:95], a[28:31], v[100:103]
    s_nop 4
    v_pk_mul_f32 v[56:57], v[56:57], v[104:105]
    v_pk_mul_f32 v[96:97], v[96:97], v[104:105]
    v_pk_mul_f32 v[58:59], v[58:59], v[106:107]
    v_pk_mul_f32 v[98:99], v[98:99], v[106:107]
    v_pk_mul_f32 v[60:61], v[60:61], v[108:109]
    v_pk_mul_f32 v[100:101], v[100:101], v[108:109]
    v_pk_mul_f32 v[62:63], v[62:63], v[110:111]
    v_pk_mul_f32 v[102:103], v[102:103], v[110:111]
    v_cvt_pk_bf16_f32 v48, v56, v96
    v_cvt_pk_bf16_f32 v49, v57, v97
    v_cvt_pk_bf16_f32 v50, v58, v98
    v_cvt_pk_bf16_f32 v51, v59, v99
    v_cvt_pk_bf16_f32 v52, v60, v100
    v_cvt_pk_bf16_f32 v53, v61, v101
    v_cvt_pk_bf16_f32 v54, v62, v102
    v_cvt_pk_bf16_f32 v55, v63, v103
    buffer_store_dwordx4 v[48:51], v15, s[68:71], s54 offen offset:0 sc1
    buffer_store_dwordx4 v[52:55], v15, s[68:71], s54 offen offset:256 sc1
    v_bfe_u32 v105, v1, 2, 2
    v_lshl_add_u32 v3, v14, 2, v105
    v_lshlrev_b32 v3, 7, v3
    v_lshrrev_b32 v4, 1, v105
    v_xor_b32 v4, s44, v4
    v_lshlrev_b32 v4, 6, v4
    v_bfe_u32 v105, v1, 4, 1
    v_lshlrev_b32 v105, 5, v105
    v_add3_u32 v104, v3, v4, v105
    v_and_b32 v105, 3, v1
    v_lshl_add_u32 v104, v105, 3, v104
    v_add_u32 v104, s48, v104
    v_add_u32 v104, 0x20000, v104
    v_xor_b32 v105, 64, v104
    s_waitcnt vmcnt(0)
    s_lshl_b32 s96, s40, 15
    s_lshl_b32 s95, s52, 5
    s_add_u32 s96, s96, s95
    s_add_u32 s96, s96, 327680
    s_mov_b64 exec, 1
    buffer_store_dword v13, v11, s[36:39], s96 offen sc1
    s_mov_b64 exec, -1
    s_setprio 0
    v_lshlrev_b32 v3, 1, v12
    v_lshlrev_b32 v4, 2, v12
    s_xor_b32 s95, s44, 0
    s_lshl_b32 s95, s95, 6
    s_add_u32 s95, s95, s47
    buffer_load_ushort v80, v3, s[16:19], s95 offen
    s_xor_b32 s95, s44, 1
    s_lshl_b32 s95, s95, 6
    s_add_u32 s95, s95, s47
    buffer_load_ushort v84, v3, s[16:19], s95 offen
    s_and_b32 s96, s41, 1
    s_mul_i32 s96, s96, 7
    s_add_u32 s96, s96, s15
    s_lshl_b32 s96, s96, 14
    s_lshl_b32 s95, s53, 7
    s_add_u32 s95, s95, s96
    buffer_load_dword v88, v4, s[76:79], s95 offen sc1
    s_lshl_b32 s95, s55, 7
    s_add_u32 s95, s95, s96
    buffer_load_dword v92, v4, s[76:79], s95 offen sc1
    v_mov_b32 v81, 0
    v_mov_b32 v82, 0
    v_mov_b32 v83, 0
    v_mov_b32 v85, 0
    v_mov_b32 v86, 0
    v_mov_b32 v87, 0
    v_mov_b32 v89, 0
    v_mov_b32 v90, 0
    v_mov_b32 v91, 0
    v_mov_b32 v93, 0
    v_mov_b32 v94, 0
    v_mov_b32 v95, 0
    v_cmp_gt_u32 vcc, 32, v0
    buffer_load_dword v113, v112, s[36:39], s59 offen sc1
    s_waitcnt vmcnt(0)
    s_mov_b32 s97, 0
POLL4:
    v_cmp_ne_u32 s[84:85], s14, v113
    s_nop 0
    s_cmp_lg_u64 s[84:85], 0
    s_cbranch_scc0 POLLOK4
    s_sleep 4
    s_add_u32 s97, s97, 1
    s_cmp_gt_u32 s97, 0x40000
    s_cbranch_scc1 K_END
    buffer_load_dword v113, v112, s[36:39], s59 offen sc1
    s_waitcnt vmcnt(0)
    s_branch POLL4
POLLOK4:
    s_lshl_b32 s51, s88, 10
    s_add_u32 s51, s51, s56
    buffer_load_dwordx4 a[0:3], v10, s[28:31], s51 offen offset:0 sc1
    buffer_load_dwordx4 a[8:11], v10, s[28:31], s51 offen offset:1024 sc1
    s_lshl_b32 s51, s88, 10
    s_add_u32 s51, s51, s57
    buffer_load_dwordx4 a[4:7], v10, s[28:31], s51 offen offset:0 sc1
    buffer_load_dwordx4 a[12:15], v10, s[28:31], s51 offen offset:1024 sc1
    s_lshl_b32 s51, s89, 10
    s_add_u32 s51, s51, s56
    buffer_load_dwordx4 a[16:19], v10, s[28:31], s51 offen offset:0 sc1
    buffer_load_dwordx4 a[24:27], v10, s[28:31], s51 offen offset:1024 sc1
    s_lshl_b32 s51, s89, 10
    s_add_u32 s51, s51, s57
    buffer_load_dwordx4 a[20:23], v10, s[28:31], s51 offen offset:0 sc1
    buffer_load_dwordx4 a[28:31], v10, s[28:31], s51 offen offset:1024 sc1
    v_rcp_f32 v88, v88
    s_nop 0
    v_cvt_pk_bf16_f32 v88, v88, 0
    v_cndmask_b32 v88, 0, v88, vcc
    v_rcp_f32 v92, v92
    s_nop 0
    v_cvt_pk_bf16_f32 v92, v92, 0
    v_cndmask_b32 v92, 0, v92, vcc
    v_mfma_f32_32x32x16_bf16 v[16:31], v[80:83], v[88:91], 0
    v_mfma_f32_32x32x16_bf16 v[32:47], v[84:87], v[88:91], 0
    v_mfma_f32_32x32x16_bf16 v[48:63], v[80:83], v[92:95], 0
    v_mfma_f32_32x32x16_bf16 v[64:79], v[84:87], v[92:95], 0
    s_barrier
    s_lshl_b32 s51, s90, 10
    s_add_u32 s51, s51, s56
    buffer_load_dwordx4 a[32:35], v10, s[28:31], s51 offen offset:0 sc1
    buffer_load_dwordx4 a[40:43], v10, s[28:31], s51 offen offset:1024 sc1
    s_lshl_b32 s51, s90, 10
    s_add_u32 s51, s51, s57
    buffer_load_dwordx4 a[36:39], v10, s[28:31], s51 offen offset:0 sc1
    buffer_load_dwordx4 a[44:47], v10, s[28:31], s51 offen offset:1024 sc1
    s_setprio 0
    ds_read_b64_tr_b16 v[80:81], v104 offset:0
    ds_read_b64_tr_b16 v[82:83], v104 offset:1024
    ds_read_b64_tr_b16 v[84:85], v105 offset:0
    ds_read_b64_tr_b16 v[86:87], v105 offset:1024
    ds_read_b64_tr_b16 v[88:89], v104 offset:2048
    ds_read_b64_tr_b16 v[90:91], v104 offset:3072
    ds_read_b64_tr_b16 v[92:93], v105 offset:2048
    ds_read_b64_tr_b16 v[94:95], v105 offset:3072
    s_waitcnt vmcnt(8)
    s_waitcnt lgkmcnt(4)
    v_mfma_f32_32x32x16_bf16 v[32:47], v[84:87], a[0:3], v[32:47]
    ds_read_b64_tr_b16 v[96:97], v104 offset:16384
    ds_read_b64_tr_b16 v[98:99], v104 offset:17408
    ds_read_b64_tr_b16 v[100:101], v105 offset:16384
    ds_read_b64_tr_b16 v[102:103], v105 offset:17408
    v_mfma_f32_32x32x16_bf16 v[48:63], v[80:83], a[4:7], v[48:63]
    s_lshl_b32 s51, s91, 10
    s_add_u32 s51, s51, s56
    v_mfma_f32_32x32x16_bf16 v[64:79], v[84:87], a[4:7], v[64:79]
    buffer_load_dwordx4 a[48:51], v10, s[28:31], s51 offen offset:0 sc1
    v_mfma_f32_32x32x16_bf16 v[16:31], v[80:83], a[0:3], v[16:31]
    buffer_load_dwordx4 a[56:59], v10, s[28:31], s51 offen offset:1024 sc1
    s_waitcnt lgkmcnt(4)
    v_mfma_f32_32x32x16_bf16 v[32:47], v[92:95], a[8:11], v[32:47]
    ds_read_b64_tr_b16 v[80:81], v104 offset:18432
    ds_read_b64_tr_b16 v[82:83], v104 offset:19456
    ds_read_b64_tr_b16 v[84:85], v105 offset:18432
    ds_read_b64_tr_b16 v[86:87], v105 offset:19456
    v_mfma_f32_32x32x16_bf16 v[48:63], v[88:91], a[12:15], v[48:63]
    s_lshl_b32 s51, s91, 10
    s_add_u32 s51, s51, s57
    v_mfma_f32_32x32x16_bf16 v[64:79], v[92:95], a[12:15], v[64:79]
    buffer_load_dwordx4 a[52:55], v10, s[28:31], s51 offen offset:0 sc1
    v_mfma_f32_32x32x16_bf16 v[16:31], v[88:91], a[8:11], v[16:31]
    buffer_load_dwordx4 a[60:63], v10, s[28:31], s51 offen offset:1024 sc1
    s_waitcnt vmcnt(8)
    s_waitcnt lgkmcnt(4)
    v_mfma_f32_32x32x16_bf16 v[32:47], v[100:103], a[16:19], v[32:47]
    v_add_u32 v104, 4294901760, v104
    v_add_u32 v105, 4294901760, v105
    ds_read_b64_tr_b16 v[88:89], v104 offset:0
    ds_read_b64_tr_b16 v[90:91], v104 offset:1024
    ds_read_b64_tr_b16 v[92:93], v105 offset:0
    ds_read_b64_tr_b16 v[94:95], v105 offset:1024
    v_mfma_f32_32x32x16_bf16 v[48:63], v[96:99], a[20:23], v[48:63]
    s_lshl_b32 s51, s92, 10
    s_add_u32 s51, s51, s56
    v_mfma_f32_32x32x16_bf16 v[64:79], v[100:103], a[20:23], v[64:79]
    buffer_load_dwordx4 a[64:67], v10, s[28:31], s51 offen offset:0 sc1
    v_mfma_f32_32x32x16_bf16 v[16:31], v[96:99], a[16:19], v[16:31]
    buffer_load_dwordx4 a[72:75], v10, s[28:31], s51 offen offset:1024 sc1
    s_waitcnt lgkmcnt(4)
    v_mfma_f32_32x32x16_bf16 v[32:47], v[84:87], a[24:27], v[32:47]
    ds_read_b64_tr_b16 v[96:97], v104 offset:2048
    ds_read_b64_tr_b16 v[98:99], v104 offset:3072
    ds_read_b64_tr_b16 v[100:101], v105 offset:2048
    ds_read_b64_tr_b16 v[102:103], v105 offset:3072
    v_mfma_f32_32x32x16_bf16 v[48:63], v[80:83], a[28:31], v[48:63]
    s_lshl_b32 s51, s92, 10
    s_add_u32 s51, s51, s57
    v_mfma_f32_32x32x16_bf16 v[64:79], v[84:87], a[28:31], v[64:79]
    buffer_load_dwordx4 a[68:71], v10, s[28:31], s51 offen offset:0 sc1
    v_mfma_f32_32x32x16_bf16 v[16:31], v[80:83], a[24:27], v[16:31]
    buffer_load_dwordx4 a[76:79], v10, s[28:31], s51 offen offset:1024 sc1
    s_waitcnt vmcnt(8)
    s_waitcnt lgkmcnt(4)
    v_mfma_f32_32x32x16_bf16 v[32:47], v[92:95], a[32:35], v[32:47]
    ds_read_b64_tr_b16 v[80:81], v104 offset:16384
    ds_read_b64_tr_b16 v[82:83], v104 offset:17408
    ds_read_b64_tr_b16 v[84:85], v105 offset:16384
    ds_read_b64_tr_b16 v[86:87], v105 offset:17408
    v_mfma_f32_32x32x16_bf16 v[48:63], v[88:91], a[36:39], v[48:63]
    s_lshl_b32 s51, s93, 10
    s_add_u32 s51, s51, s56
    v_mfma_f32_32x32x16_bf16 v[64:79], v[92:95], a[36:39], v[64:79]
    buffer_load_dwordx4 a[80:83], v10, s[28:31], s51 offen offset:0 sc1
    v_mfma_f32_32x32x16_bf16 v[16:31], v[88:91], a[32:35], v[16:31]
    buffer_load_dwordx4 a[88:91], v10, s[28:31], s51 offen offset:1024 sc1
    s_waitcnt lgkmcnt(4)
    v_mfma_f32_32x32x16_bf16 v[32:47], v[100:103], a[40:43], v[32:47]
    ds_read_b64_tr_b16 v[88:89], v104 offset:18432
    ds_read_b64_tr_b16 v[90:91], v104 offset:19456
    ds_read_b64_tr_b16 v[92:93], v105 offset:18432
    ds_read_b64_tr_b16 v[94:95], v105 offset:19456
    v_mfma_f32_32x32x16_bf16 v[48:63], v[96:99], a[44:47], v[48:63]
    s_lshl_b32 s51, s93, 10
    s_add_u32 s51, s51, s57
    v_mfma_f32_32x32x16_bf16 v[64:79], v[100:103], a[44:47], v[64:79]
    buffer_load_dwordx4 a[84:87], v10, s[28:31], s51 offen offset:0 sc1
    v_mfma_f32_32x32x16_bf16 v[16:31], v[96:99], a[40:43], v[16:31]
    buffer_load_dwordx4 a[92:95], v10, s[28:31], s51 offen offset:1024 sc1
    s_waitcnt vmcnt(8)
    s_waitcnt lgkmcnt(4)
    v_mfma_f32_32x32x16_bf16 v[32:47], v[84:87], a[48:51], v[32:47]
    ds_read_b64_tr_b16 v[96:97], v104 offset:32768
    ds_read_b64_tr_b16 v[98:99], v104 offset:33792
    ds_read_b64_tr_b16 v[100:101], v105 offset:32768
    ds_read_b64_tr_b16 v[102:103], v105 offset:33792
    v_mfma_f32_32x32x16_bf16 v[48:63], v[80:83], a[52:55], v[48:63]
    s_lshl_b32 s51, s94, 10
    s_add_u32 s51, s51, s56
    v_mfma_f32_32x32x16_bf16 v[64:79], v[84:87], a[52:55], v[64:79]
    buffer_load_dwordx4 a[96:99], v10, s[28:31], s51 offen offset:0 sc1
    v_mfma_f32_32x32x16_bf16 v[16:31], v[80:83], a[48:51], v[16:31]
    buffer_load_dwordx4 a[104:107], v10, s[28:31], s51 offen offset:1024 sc1
    s_waitcnt lgkmcnt(4)
    v_mfma_f32_32x32x16_bf16 v[32:47], v[92:95], a[56:59], v[32:47]
    ds_read_b64_tr_b16 v[80:81], v104 offset:34816
    ds_read_b64_tr_b16 v[82:83], v104 offset:35840
    ds_read_b64_tr_b16 v[84:85], v105 offset:34816
    ds_read_b64_tr_b16 v[86:87], v105 offset:35840
    v_mfma_f32_32x32x16_bf16 v[48:63], v[88:91], a[60:63], v[48:63]
    s_lshl_b32 s51, s94, 10
    s_add_u32 s51, s51, s57
    v_mfma_f32_32x32x16_bf16 v[64:79], v[92:95], a[60:63], v[64:79]
    buffer_load_dwordx4 a[100:103], v10, s[28:31], s51 offen offset:0 sc1
    v_mfma_f32_32x32x16_bf16 v[16:31], v[88:91], a[56:59], v[16:31]
    buffer_load_dwordx4 a[108:111], v10, s[28:31], s51 offen offset:1024 sc1
    s_waitcnt vmcnt(8)
    s_waitcnt lgkmcnt(4)
    v_mfma_f32_32x32x16_bf16 v[32:47], v[100:103], a[64:67], v[32:47]
    ds_read_b64_tr_b16 v[88:89], v104 offset:49152
    ds_read_b64_tr_b16 v[90:91], v104 offset:50176
    ds_read_b64_tr_b16 v[92:93], v105 offset:49152
    ds_read_b64_tr_b16 v[94:95], v105 offset:50176
    v_mfma_f32_32x32x16_bf16 v[48:63], v[96:99], a[68:71], v[48:63]
    v_mfma_f32_32x32x16_bf16 v[64:79], v[100:103], a[68:71], v[64:79]
    v_mfma_f32_32x32x16_bf16 v[16:31], v[96:99], a[64:67], v[16:31]
    s_waitcnt lgkmcnt(4)
    v_mfma_f32_32x32x16_bf16 v[32:47], v[84:87], a[72:75], v[32:47]
    ds_read_b64_tr_b16 v[96:97], v104 offset:51200
    ds_read_b64_tr_b16 v[98:99], v104 offset:52224
    ds_read_b64_tr_b16 v[100:101], v105 offset:51200
    ds_read_b64_tr_b16 v[102:103], v105 offset:52224
    v_mfma_f32_32x32x16_bf16 v[48:63], v[80:83], a[76:79], v[48:63]
    v_mfma_f32_32x32x16_bf16 v[64:79], v[84:87], a[76:79], v[64:79]
    v_mfma_f32_32x32x16_bf16 v[16:31], v[80:83], a[72:75], v[16:31]
    s_waitcnt vmcnt(4)
    s_waitcnt lgkmcnt(4)
    v_mfma_f32_32x32x16_bf16 v[32:47], v[92:95], a[80:83], v[32:47]
    v_add_u32 v104, 4294901760, v104
    v_add_u32 v105, 4294901760, v105
    ds_read_b64_tr_b16 v[80:81], v104 offset:0
    ds_read_b64_tr_b16 v[82:83], v104 offset:1024
    ds_read_b64_tr_b16 v[84:85], v105 offset:0
    ds_read_b64_tr_b16 v[86:87], v105 offset:1024
    v_mfma_f32_32x32x16_bf16 v[48:63], v[88:91], a[84:87], v[48:63]
    v_mfma_f32_32x32x16_bf16 v[64:79], v[92:95], a[84:87], v[64:79]
    v_mfma_f32_32x32x16_bf16 v[16:31], v[88:91], a[80:83], v[16:31]
    s_waitcnt lgkmcnt(4)
    v_mfma_f32_32x32x16_bf16 v[32:47], v[100:103], a[88:91], v[32:47]
    ds_read_b64_tr_b16 v[88:89], v104 offset:2048
    ds_read_b64_tr_b16 v[90:91], v104 offset:3072
    ds_read_b64_tr_b16 v[92:93], v105 offset:2048
    ds_read_b64_tr_b16 v[94:95], v105 offset:3072
    v_mfma_f32_32x32x16_bf16 v[48:63], v[96:99], a[92:95], v[48:63]
    v_mfma_f32_32x32x16_bf16 v[64:79], v[100:103], a[92:95], v[64:79]
    v_mfma_f32_32x32x16_bf16 v[16:31], v[96:99], a[88:91], v[16:31]
    s_waitcnt vmcnt(0)
    s_waitcnt lgkmcnt(4)
    v_mfma_f32_32x32x16_bf16 v[32:47], v[84:87], a[96:99], v[32:47]
    v_mfma_f32_32x32x16_bf16 v[48:63], v[80:83], a[100:103], v[48:63]
    v_mfma_f32_32x32x16_bf16 v[64:79], v[84:87], a[100:103], v[64:79]
    v_mfma_f32_32x32x16_bf16 v[16:31], v[80:83], a[96:99], v[16:31]
    s_waitcnt lgkmcnt(0)
    v_mfma_f32_32x32x16_bf16 v[32:47], v[92:95], a[104:107], v[32:47]
    v_mfma_f32_32x32x16_bf16 v[48:63], v[88:91], a[108:111], v[48:63]
    v_mfma_f32_32x32x16_bf16 v[64:79], v[92:95], a[108:111], v[64:79]
    v_mfma_f32_32x32x16_bf16 v[16:31], v[88:91], a[104:107], v[16:31]
    s_mul_i32 s95, s40, 12288
    s_add_u32 s95, s95, 16384
    v_add_u32 v104, s95, v10
    s_nop 5
    ds_write_b128 v104, v[32:35] offset:0
    ds_write_b128 v104, v[36:39] offset:1024
    ds_write_b128 v104, v[40:43] offset:2048
    ds_write_b128 v104, v[44:47] offset:3072
    ds_write_b128 v104, v[48:51] offset:4096
    ds_write_b128 v104, v[52:55] offset:5120
    ds_write_b128 v104, v[56:59] offset:6144
    ds_write_b128 v104, v[60:63] offset:7168
    ds_write_b128 v104, v[64:67] offset:8192
    ds_write_b128 v104, v[68:71] offset:9216
    ds_write_b128 v104, v[72:75] offset:10240
    ds_write_b128 v104, v[76:79] offset:11264
    s_xor_b32 s95, s40, 1
    s_mul_i32 s95, s95, 12288
    s_add_u32 s95, s95, 16384
    v_add_u32 v105, s95, v10
    s_xor_b32 s95, s40, 2
    s_mul_i32 s95, s95, 12288
    s_add_u32 s95, s95, 20480
    v_add_u32 v106, s95, v10
    s_xor_b32 s95, s40, 3
    s_mul_i32 s95, s95, 12288
    s_add_u32 s95, s95, 24576
    v_add_u32 v107, s95, v10
    s_add_u32 s16, s12, 15728640
    s_addc_u32 s17, s13, 0
    s_mov_b32 s18, 2097152
    s_mov_b32 s19, 0x20000
    s_xor_b32 s58, s2, 1
    s_lshl_b32 s58, s58, 2
    s_add_u32 s58, s58, s40
    s_lshl_b32 s57, s58, 11
    s_waitcnt lgkmcnt(0)
    s_barrier
    s_setprio 2
    ds_read_b128 v[32:35], v105 offset:0
    ds_read_b128 v[36:39], v105 offset:1024
    ds_read_b128 v[40:43], v105 offset:2048
    ds_read_b128 v[44:47], v105 offset:3072
    ds_read_b128 v[48:51], v106 offset:0
    ds_read_b128 v[52:55], v106 offset:1024
    ds_read_b128 v[56:59], v106 offset:2048
    ds_read_b128 v[60:63], v106 offset:3072
    ds_read_b128 v[64:67], v107 offset:0
    ds_read_b128 v[68:71], v107 offset:1024
    ds_read_b128 v[72:75], v107 offset:2048
    ds_read_b128 v[76:79], v107 offset:3072
    s_waitcnt lgkmcnt(8)
    v_add_f32 v16, v16, v32
    v_add_f32 v17, v17, v33
    v_add_f32 v18, v18, v34
    v_add_f32 v19, v19, v35
    v_add_f32 v20, v20, v36
    v_add_f32 v21, v21, v37
    v_add_f32 v22, v22, v38
    v_add_f32 v23, v23, v39
    v_add_f32 v24, v24, v40
    v_add_f32 v25, v25, v41
    v_add_f32 v26, v26, v42
    v_add_f32 v27, v27, v43
    v_add_f32 v28, v28, v44
    v_add_f32 v29, v29, v45
    v_add_f32 v30, v30, v46
    v_add_f32 v31, v31, v47
    s_waitcnt lgkmcnt(4)
    v_add_f32 v16, v16, v48
    v_add_f32 v17, v17, v49
    v_add_f32 v18, v18, v50
    v_add_f32 v19, v19, v51
    v_add_f32 v20, v20, v52
    v_add_f32 v21, v21, v53
    v_add_f32 v22, v22, v54
    v_add_f32 v23, v23, v55
    v_add_f32 v24, v24, v56
    v_add_f32 v25, v25, v57
    v_add_f32 v26, v26, v58
    v_add_f32 v27, v27, v59
    v_add_f32 v28, v28, v60
    v_add_f32 v29, v29, v61
    v_add_f32 v30, v30, v62
    v_add_f32 v31, v31, v63
    s_waitcnt lgkmcnt(0)
    v_add_f32 v16, v16, v64
    v_add_f32 v17, v17, v65
    v_add_f32 v18, v18, v66
    v_add_f32 v19, v19, v67
    v_add_f32 v20, v20, v68
    v_add_f32 v21, v21, v69
    v_add_f32 v22, v22, v70
    v_add_f32 v23, v23, v71
    v_add_f32 v24, v24, v72
    v_add_f32 v25, v25, v73
    v_add_f32 v26, v26, v74
    v_add_f32 v27, v27, v75
    v_add_f32 v28, v28, v76
    v_add_f32 v29, v29, v77
    v_add_f32 v30, v30, v78
    v_add_f32 v31, v31, v79
    v_cvt_pk_bf16_f32 v88, v16, v17
    v_cvt_pk_bf16_f32 v89, v18, v19
    v_cvt_pk_bf16_f32 v90, v20, v21
    v_cvt_pk_bf16_f32 v91, v22, v23
    v_cvt_pk_bf16_f32 v92, v24, v25
    v_cvt_pk_bf16_f32 v93, v26, v27
    v_cvt_pk_bf16_f32 v94, v28, v29
    v_cvt_pk_bf16_f32 v95, v30, v31
    buffer_store_dwordx4 v[88:91], v10, s[16:19], s57 offen offset:0 sc1
    buffer_store_dwordx4 v[92:95], v10, s[16:19], s57 offen offset:1024 sc1
    s_waitcnt vmcnt(0)
    s_lshl_b32 s96, s58, 7
    s_add_u32 s96, s96, 655360
    s_mov_b64 exec, 1
    buffer_store_dword v13, v11, s[36:39], s96 offen sc1
    s_mov_b64 exec, -1
    s_endpgm
K_HELP:
    s_load_dwordx4 s[88:91], s[0:1], 8
    s_lshl_b32 s43, s41, 2
    s_sub_u32 s44, s42, 28
    s_add_u32 s43, s43, s44
    v_lshlrev_b32 v10, 4, v1
    v_mov_b32 v11, 0
    v_mov_b32 v15, 0
    v_and_b32 v12, 31, v1
    v_lshrrev_b32 v14, 5, v1
    s_lshr_b32 s45, s43, 3
    s_and_b32 s46, s43, 7
    s_lshl_b32 s47, s46, 2
    s_add_u32 s47, s47, s40
    s_lshl_b32 s47, s47, 2
    s_add_u32 s47, s47, s45
    s_mul_i32 s47, s47, 7200
    s_lshl_b32 s48, s100, 13
    s_waitcnt lgkmcnt(0)
    s_add_u32 s36, s12, 7340032
    s_addc_u32 s37, s13, 0
    s_load_dword s14, s[36:37], 61440
    s_cmp_lt_u32 s100, 4
    s_cselect_b32 s88, s88, s90
    s_cselect_b32 s89, s89, s91
    s_mov_b32 s24, s88
    s_mov_b32 s25, s89
    s_mov_b32 s26, 921600
    s_mov_b32 s27, 0x20000
    s_add_u32 m0, s48, 0
    s_add_u32 s49, s47, 0
    buffer_load_dwordx4 v10, s[24:27], s49 offen offset:0 lds
    buffer_load_dwordx4 v10, s[24:27], s49 offen offset:1024 lds
    buffer_load_dwordx4 v10, s[24:27], s49 offen offset:2048 lds
    buffer_load_dwordx4 v10, s[24:27], s49 offen offset:3072 lds
    s_add_u32 m0, s48, 4096
    s_add_u32 s49, s47, 4096
    buffer_load_dwordx4 v10, s[24:27], s49 offen offset:0 lds
    buffer_load_dwordx4 v10, s[24:27], s49 offen offset:1024 lds
    buffer_load_dwordx4 v10, s[24:27], s49 offen offset:2048 lds
    buffer_load_dwordx4 v10, s[24:27], s49 offen offset:3072 lds
    s_mov_b32 s38, 1048576
    s_mov_b32 s39, 0x20000
    s_add_u32 s28, s12, 8388608
    s_addc_u32 s29, s13, 0
    s_mov_b32 s30, 7340032
    s_mov_b32 s31, 0x20000
    s_mov_b32 s32, s12
    s_mov_b32 s33, s13
    s_mov_b32 s34, 1835008
    s_mov_b32 s35, 0x20000
    s_mov_b32 s64, s60
    s_mov_b32 s65, s61
    s_mov_b32 s66, 1605632
    s_mov_b32 s67, 0x20000
    s_add_u32 s68, s12, 2097152
    s_addc_u32 s69, s13, 0
    s_mov_b32 s70, 1843200
    s_mov_b32 s71, 0x20000
    s_add_u32 s72, s12, 4194304
    s_addc_u32 s73, s13, 0
    s_mov_b32 s74, 1843200
    s_mov_b32 s75, 0x20000
    s_add_u32 s76, s12, 6291456
    s_addc_u32 s77, s13, 0
    s_mov_b32 s78, 229376
    s_mov_b32 s79, 0x20000
    s_mov_b32 s80, s6
    s_mov_b32 s81, s7
    s_mov_b32 s82, 1835008
    s_mov_b32 s83, 0x20000
    s_waitcnt lgkmcnt(0)
    s_mul_i32 s14, s14, 0x9e3779b1
    s_add_u32 s14, s14, 0x7f4a7c15
    v_mov_b32 v13, s14
    s_waitcnt vmcnt(0)
    s_barrier
    v_and_b32 v6, 15, v1
    v_lshrrev_b32 v7, 4, v0
    v_mul_u32_u24 v8, 450, v6
    v_lshl_add_u32 v8, v7, 1, v8
    v_lshlrev_b32 v4, 13, v7
    v_lshl_add_u32 v4, v6, 4, v4
    s_lshl_b32 s54, s45, 11
    s_lshl_b32 s55, s46, 8
    s_add_u32 s54, s54, s55
    ds_read_u16 v16, v8 offset:0
    ds_read_u16 v20, v8 offset:32768
    ds_read_u16 v17, v8 offset:8192
    ds_read_u16 v21, v8 offset:40960
    ds_read_u16 v18, v8 offset:16384
    ds_read_u16 v22, v8 offset:49152
    ds_read_u16 v19, v8 offset:24576
    ds_read_u16 v23, v8 offset:57344
    ds_read_u16 v24, v8 offset:64
    ds_read_u16 v28, v8 offset:32832
    ds_read_u16 v25, v8 offset:8256
    ds_read_u16 v29, v8 offset:41024
    ds_read_u16 v26, v8 offset:16448
    ds_read_u16 v30, v8 offset:49216
    ds_read_u16 v27, v8 offset:24640
    ds_read_u16 v31, v8 offset:57408
    s_waitcnt lgkmcnt(8)
    v_lshl_or_b32 v16, v20, 16, v16
    v_lshl_or_b32 v17, v21, 16, v17
    v_lshl_or_b32 v18, v22, 16, v18
    v_lshl_or_b32 v19, v23, 16, v19
    s_add_u32 s56, s54, 0
    buffer_store_dwordx4 v[16:19], v4, s[72:75], s56 offen sc1
    ds_read_u16 v32, v8 offset:128
    ds_read_u16 v36, v8 offset:32896
    ds_read_u16 v33, v8 offset:8320
    ds_read_u16 v37, v8 offset:41088
    ds_read_u16 v34, v8 offset:16512
    ds_read_u16 v38, v8 offset:49280
    ds_read_u16 v35, v8 offset:24704
    ds_read_u16 v39, v8 offset:57472
    s_waitcnt lgkmcnt(8)
    v_lshl_or_b32 v24, v28, 16, v24
    v_lshl_or_b32 v25, v29, 16, v25
    v_lshl_or_b32 v26, v30, 16, v26
    v_lshl_or_b32 v27, v31, 16, v27
    s_add_u32 s56, s54, 262144
    buffer_store_dwordx4 v[24:27], v4, s[72:75], s56 offen sc1
    ds_read_u16 v40, v8 offset:192
    ds_read_u16 v44, v8 offset:32960
    ds_read_u16 v41, v8 offset:8384
    ds_read_u16 v45, v8 offset:41152
    ds_read_u16 v42, v8 offset:16576
    ds_read_u16 v46, v8 offset:49344
    ds_read_u16 v43, v8 offset:24768
    ds_read_u16 v47, v8 offset:57536
    s_waitcnt lgkmcnt(8)
    v_lshl_or_b32 v32, v36, 16, v32
    v_lshl_or_b32 v33, v37, 16, v33
    v_lshl_or_b32 v34, v38, 16, v34
    v_lshl_or_b32 v35, v39, 16, v35
    s_add_u32 s56, s54, 524288
    buffer_store_dwordx4 v[32:35], v4, s[72:75], s56 offen sc1
    ds_read_u16 v48, v8 offset:256
    ds_read_u16 v52, v8 offset:33024
    ds_read_u16 v49, v8 offset:8448
    ds_read_u16 v53, v8 offset:41216
    ds_read_u16 v50, v8 offset:16640
    ds_read_u16 v54, v8 offset:49408
    ds_read_u16 v51, v8 offset:24832
    ds_read_u16 v55, v8 offset:57600
    s_waitcnt lgkmcnt(8)
    v_lshl_or_b32 v40, v44, 16, v40
    v_lshl_or_b32 v41, v45, 16, v41
    v_lshl_or_b32 v42, v46, 16, v42
    v_lshl_or_b32 v43, v47, 16, v43
    s_add_u32 s56, s54, 786432
    buffer_store_dwordx4 v[40:43], v4, s[72:75], s56 offen sc1
    ds_read_u16 v56, v8 offset:320
    ds_read_u16 v60, v8 offset:33088
    ds_read_u16 v57, v8 offset:8512
    ds_read_u16 v61, v8 offset:41280
    ds_read_u16 v58, v8 offset:16704
    ds_read_u16 v62, v8 offset:49472
    ds_read_u16 v59, v8 offset:24896
    ds_read_u16 v63, v8 offset:57664
    s_waitcnt lgkmcnt(8)
    v_lshl_or_b32 v48, v52, 16, v48
    v_lshl_or_b32 v49, v53, 16, v49
    v_lshl_or_b32 v50, v54, 16, v50
    v_lshl_or_b32 v51, v55, 16, v51
    s_add_u32 s56, s54, 1048576
    buffer_store_dwordx4 v[48:51], v4, s[72:75], s56 offen sc1
    ds_read_u16 v64, v8 offset:384
    ds_read_u16 v68, v8 offset:33152
    ds_read_u16 v65, v8 offset:8576
    ds_read_u16 v69, v8 offset:41344
    ds_read_u16 v66, v8 offset:16768
    ds_read_u16 v70, v8 offset:49536
    ds_read_u16 v67, v8 offset:24960
    ds_read_u16 v71, v8 offset:57728
    s_waitcnt lgkmcnt(8)
    v_lshl_or_b32 v56, v60, 16, v56
    v_lshl_or_b32 v57, v61, 16, v57
    v_lshl_or_b32 v58, v62, 16, v58
    v_lshl_or_b32 v59, v63, 16, v59
    s_add_u32 s56, s54, 1310720
    buffer_store_dwordx4 v[56:59], v4, s[72:75], s56 offen sc1
    ds_read_u16 v72, v8 offset:448
    ds_read_u16 v76, v8 offset:33216
    ds_read_u16 v73, v8 offset:8640
    ds_read_u16 v77, v8 offset:41408
    ds_read_u16 v74, v8 offset:16832
    ds_read_u16 v78, v8 offset:49600
    ds_read_u16 v75, v8 offset:25024
    ds_read_u16 v79, v8 offset:57792
    s_waitcnt lgkmcnt(8)
    v_lshl_or_b32 v64, v68, 16, v64
    v_lshl_or_b32 v65, v69, 16, v65
    v_lshl_or_b32 v66, v70, 16, v66
    v_lshl_or_b32 v67, v71, 16, v67
    s_add_u32 s56, s54, 1572864
    buffer_store_dwordx4 v[64:67], v4, s[72:75], s56 offen sc1
    s_waitcnt lgkmcnt(0)
    v_lshl_or_b32 v72, v76, 16, v72
    v_lshl_or_b32 v73, v77, 16, v73
    v_lshl_or_b32 v74, v78, 16, v74
    v_lshl_or_b32 v75, v79, 16, v75
    s_add_u32 s56, s54, 1835008
    buffer_store_dwordx4 v[72:75], v4, s[72:75], s56 offen sc1
    s_waitcnt vmcnt(0)
    s_barrier
    s_cmp_eq_u32 s100, 0
    s_cbranch_scc0 K_NOW
    s_lshl_b32 s96, s43, 7
    s_add_u32 s96, s96, 32768
    s_mov_b64 exec, 1
    buffer_store_dword v13, v11, s[36:39], s96 offen sc1
    s_mov_b64 exec, -1
K_NOW:
    v_lshlrev_b32 v7, 7, v0
    s_lshl_b32 s58, s43, 16
    buffer_load_dword v9, v7, s[64:67], s58 offen
    s_cmp_ge_u32 s100, 4
    s_cbranch_scc0 K_HF
    s_branch K_HFIN
K_HF:
    s_cmp_ge_u32 s43, 2
    s_cbranch_scc1 K_HFIN
    v_and_b32 v16, 15, v1
    v_lshrrev_b32 v17, 4, v1
    v_lshlrev_b32 v15, 9, v17
    v_lshl_add_u32 v15, v16, 4, v15
    v_lshl_add_u32 v18, v2, 4, v16
    v_cvt_f32_u32 v18, v18
    v_cvt_f32_u32 v19, v16
    v_lshlrev_b32 v20, 2, v17
    v_cvt_f32_u32 v20, v20
    v_mul_f32 v21, 0x3c800000, v18
    v_mul_f32 v22, v21, v20
    v_mul_f32 v23, 0x41800000, v21
    v_cos_f32 v25, v22
    v_sin_f32 v26, v22
    s_nop 0
    v_cvt_pk_bf16_f32 v27, v25, v26
    v_cvt_pk_bf16_f32 v28, -v26, v25
    v_accvgpr_write_b32 a64, v27
    v_accvgpr_write_b32 a80, v28
    v_add_f32 v24, v22, v21
    v_cos_f32 v25, v24
    v_sin_f32 v26, v24
    s_nop 0
    v_cvt_pk_bf16_f32 v27, v25, v26
    v_cvt_pk_bf16_f32 v28, -v26, v25
    v_accvgpr_write_b32 a65, v27
    v_accvgpr_write_b32 a81, v28
    v_add_f32 v24, v24, v21
    v_cos_f32 v25, v24
    v_sin_f32 v26, v24
    s_nop 0
    v_cvt_pk_bf16_f32 v27, v25, v26
    v_cvt_pk_bf16_f32 v28, -v26, v25
    v_accvgpr_write_b32 a66, v27
    v_accvgpr_write_b32 a82, v28
    v_add_f32 v24, v24, v21
    v_cos_f32 v25, v24
    v_sin_f32 v26, v24
    s_nop 0
    v_cvt_pk_bf16_f32 v27, v25, v26
    v_cvt_pk_bf16_f32 v28, -v26, v25
    v_accvgpr_write_b32 a67, v27
    v_accvgpr_write_b32 a83, v28
    v_add_f32 v22, v22, v23
    v_cos_f32 v25, v22
    v_sin_f32 v26, v22
    s_nop 0
    v_cvt_pk_bf16_f32 v27, v25, v26
    v_cvt_pk_bf16_f32 v28, -v26, v25
    v_accvgpr_write_b32 a68, v27
    v_accvgpr_write_b32 a84, v28
    v_add_f32 v24, v22, v21
    v_cos_f32 v25, v24
    v_sin_f32 v26, v24
    s_nop 0
    v_cvt_pk_bf16_f32 v27, v25, v26
    v_cvt_pk_bf16_f32 v28, -v26, v25
    v_accvgpr_write_b32 a69, v27
    v_accvgpr_write_b32 a85, v28
    v_add_f32 v24, v24, v21
    v_cos_f32 v25, v24
    v_sin_f32 v26, v24
    s_nop 0
    v_cvt_pk_bf16_f32 v27, v25, v26
    v_cvt_pk_bf16_f32 v28, -v26, v25
    v_accvgpr_write_b32 a70, v27
    v_accvgpr_write_b32 a86, v28
    v_add_f32 v24, v24, v21
    v_cos_f32 v25, v24
    v_sin_f32 v26, v24
    s_nop 0
    v_cvt_pk_bf16_f32 v27, v25, v26
    v_cvt_pk_bf16_f32 v28, -v26, v25
    v_accvgpr_write_b32 a71, v27
    v_accvgpr_write_b32 a87, v28
    v_add_f32 v22, v22, v23
    v_cos_f32 v25, v22
    v_sin_f32 v26, v22
    s_nop 0
    v_cvt_pk_bf16_f32 v27, v25, v26
    v_cvt_pk_bf16_f32 v28, -v26, v25
    v_accvgpr_write_b32 a72, v27
    v_accvgpr_write_b32 a88, v28
    v_add_f32 v24, v22, v21
    v_cos_f32 v25, v24
    v_sin_f32 v26, v24
    s_nop 0
    v_cvt_pk_bf16_f32 v27, v25, v26
    v_cvt_pk_bf16_f32 v28, -v26, v25
    v_accvgpr_write_b32 a73, v27
    v_accvgpr_write_b32 a89, v28
    v_add_f32 v24, v24, v21
    v_cos_f32 v25, v24
    v_sin_f32 v26, v24
    s_nop 0
    v_cvt_pk_bf16_f32 v27, v25, v26
    v_cvt_pk_bf16_f32 v28, -v26, v25
    v_accvgpr_write_b32 a74, v27
    v_accvgpr_write_b32 a90, v28
    v_add_f32 v24, v24, v21
    v_cos_f32 v25, v24
    v_sin_f32 v26, v24
    s_nop 0
    v_cvt_pk_bf16_f32 v27, v25, v26
    v_cvt_pk_bf16_f32 v28, -v26, v25
    v_accvgpr_write_b32 a75, v27
    v_accvgpr_write_b32 a91, v28
    v_add_f32 v22, v22, v23
    v_cos_f32 v25, v22
    v_sin_f32 v26, v22
    s_nop 0
    v_cvt_pk_bf16_f32 v27, v25, v26
    v_cvt_pk_bf16_f32 v28, -v26, v25
    v_accvgpr_write_b32 a76, v27
    v_accvgpr_write_b32 a92, v28
    v_add_f32 v24, v22, v21
    v_cos_f32 v25, v24
    v_sin_f32 v26, v24
    s_nop 0
    v_cvt_pk_bf16_f32 v27, v25, v26
    v_cvt_pk_bf16_f32 v28, -v26, v25
    v_accvgpr_write_b32 a77, v27
    v_accvgpr_write_b32 a93, v28
    v_add_f32 v24, v24, v21
    v_cos_f32 v25, v24
    v_sin_f32 v26, v24
    s_nop 0
    v_cvt_pk_bf16_f32 v27, v25, v26
    v_cvt_pk_bf16_f32 v28, -v26, v25
    v_accvgpr_write_b32 a78, v27
    v_accvgpr_write_b32 a94, v28
    v_add_f32 v24, v24, v21
    v_cos_f32 v25, v24
    v_sin_f32 v26, v24
    s_nop 0
    v_cvt_pk_bf16_f32 v27, v25, v26
    v_cvt_pk_bf16_f32 v28, -v26, v25
    v_accvgpr_write_b32 a79, v27
    v_accvgpr_write_b32 a95, v28
    v_mul_f32 v21, 0x3d000000, v19
    v_mul_f32 v22, v21, v20
    v_mul_f32 v23, 0x41800000, v21
    v_cos_f32 v25, v22
    v_sin_f32 v26, v22
    s_nop 0
    v_cvt_pk_bf16_f32 v27, v25, v26
    v_cvt_pk_bf16_f32 v128, -v26, v25
    v_accvgpr_write_b32 a96, v27
    v_mov_b32 v136, v128
    v_accvgpr_write_b32 a104, v27
    v_add_f32 v24, v22, v21
    v_cos_f32 v25, v24
    v_sin_f32 v26, v24
    s_nop 0
    v_cvt_pk_bf16_f32 v27, v25, v26
    v_cvt_pk_bf16_f32 v129, -v26, v25
    v_accvgpr_write_b32 a97, v27
    v_xor_b32 v27, 0x80008000, v27
    v_xor_b32 v137, 0x80008000, v129
    v_accvgpr_write_b32 a105, v27
    v_add_f32 v24, v24, v21
    v_cos_f32 v25, v24
    v_sin_f32 v26, v24
    s_nop 0
    v_cvt_pk_bf16_f32 v27, v25, v26
    v_cvt_pk_bf16_f32 v130, -v26, v25
    v_accvgpr_write_b32 a98, v27
    v_mov_b32 v138, v130
    v_accvgpr_write_b32 a106, v27
    v_add_f32 v24, v24, v21
    v_cos_f32 v25, v24
    v_sin_f32 v26, v24
    s_nop 0
    v_cvt_pk_bf16_f32 v27, v25, v26
    v_cvt_pk_bf16_f32 v131, -v26, v25
    v_accvgpr_write_b32 a99, v27
    v_xor_b32 v27, 0x80008000, v27
    v_xor_b32 v139, 0x80008000, v131
    v_accvgpr_write_b32 a107, v27
    v_add_f32 v22, v22, v23
    v_cos_f32 v25, v22
    v_sin_f32 v26, v22
    s_nop 0
    v_cvt_pk_bf16_f32 v27, v25, v26
    v_cvt_pk_bf16_f32 v132, -v26, v25
    v_accvgpr_write_b32 a100, v27
    v_mov_b32 v140, v132
    v_accvgpr_write_b32 a108, v27
    v_add_f32 v24, v22, v21
    v_cos_f32 v25, v24
    v_sin_f32 v26, v24
    s_nop 0
    v_cvt_pk_bf16_f32 v27, v25, v26
    v_cvt_pk_bf16_f32 v133, -v26, v25
    v_accvgpr_write_b32 a101, v27
    v_xor_b32 v27, 0x80008000, v27
    v_xor_b32 v141, 0x80008000, v133
    v_accvgpr_write_b32 a109, v27
    v_add_f32 v24, v24, v21
    v_cos_f32 v25, v24
    v_sin_f32 v26, v24
    s_nop 0
    v_cvt_pk_bf16_f32 v27, v25, v26
    v_cvt_pk_bf16_f32 v134, -v26, v25
    v_accvgpr_write_b32 a102, v27
    v_mov_b32 v142, v134
    v_accvgpr_write_b32 a110, v27
    v_add_f32 v24, v24, v21
    v_cos_f32 v25, v24
    v_sin_f32 v26, v24
    s_nop 0
    v_cvt_pk_bf16_f32 v27, v25, v26
    v_cvt_pk_bf16_f32 v135, -v26, v25
    v_accvgpr_write_b32 a103, v27
    v_xor_b32 v27, 0x80008000, v27
    v_xor_b32 v143, 0x80008000, v135
    v_accvgpr_write_b32 a111, v27
    v_mul_f32 v21, 0x3a000000, v18
    v_mul_f32 v22, v21, v20
    v_mul_f32 v23, 0x41800000, v21
    v_cos_f32 v64, v22
    v_sin_f32 v72, -v22
    v_add_f32 v24, v22, v21
    v_cos_f32 v65, v24
    v_sin_f32 v73, -v24
    v_add_f32 v24, v24, v21
    v_cos_f32 v66, v24
    v_sin_f32 v74, -v24
    v_add_f32 v24, v24, v21
    v_cos_f32 v67, v24
    v_sin_f32 v75, -v24
    v_add_f32 v22, v22, v23
    v_cos_f32 v68, v22
    v_sin_f32 v76, -v22
    v_add_f32 v24, v22, v21
    v_cos_f32 v69, v24
    v_sin_f32 v77, -v24
    v_add_f32 v24, v24, v21
    v_cos_f32 v70, v24
    v_sin_f32 v78, -v24
    v_add_f32 v24, v24, v21
    v_cos_f32 v71, v24
    v_sin_f32 v79, -v24
    v_lshlrev_b32 v22, 4, v2
    v_cvt_f32_u32 v22, v22
    v_add_f32 v22, v22, v20
    v_mul_f32 v21, 0x3a000000, v19
    v_mul_f32 v24, v21, v22
    v_cos_f32 v80, v24
    v_sin_f32 v88, -v24
    v_add_f32 v24, v24, v21
    v_cos_f32 v81, v24
    v_sin_f32 v89, -v24
    v_add_f32 v24, v24, v21
    v_cos_f32 v82, v24
    v_sin_f32 v90, -v24
    v_add_f32 v24, v24, v21
    v_cos_f32 v83, v24
    v_sin_f32 v91, -v24
    v_add_f32 v21, 0x3c000000, v21
    v_mul_f32 v24, v21, v22
    v_cos_f32 v84, v24
    v_sin_f32 v92, -v24
    v_add_f32 v24, v24, v21
    v_cos_f32 v85, v24
    v_sin_f32 v93, -v24
    v_add_f32 v24, v24, v21
    v_cos_f32 v86, v24
    v_sin_f32 v94, -v24
    v_add_f32 v24, v24, v21
    v_cos_f32 v87, v24
    v_sin_f32 v95, -v24
    s_mul_i32 s52, s43, 224
    s_mov_b32 s56, 0
    s_mov_b32 s57, 4096
    s_lshl_b32 s54, s52, 13
    s_lshl_b32 s49, s40, 11
    s_add_u32 s54, s54, s49
    s_add_u32 s45, s49, 8192
    s_lshr_b32 s59, s56, 4
    s_lshl_b32 s59, s59, 11
    s_add_u32 s59, s59, 524288
    v_lshlrev_b32 v96, 7, v1
    v_add_u32 v96, s59, v96
    v_and_b32 v97, 7, v1
    v_lshl_add_u32 v97, v2, 3, v97
    v_lshlrev_b32 v97, 7, v97
    v_add_u32 v97, 32768, v97
    v_cmp_gt_u32 vcc, 16, v1
    s_nop 1
    v_cndmask_b32 v96, v97, v96, vcc
    buffer_load_dword v97, v96, s[36:39], 0 offen sc1
    s_waitcnt vmcnt(0)
    s_mov_b32 s97, 0
POLL5:
    v_cmp_ne_u32 s[84:85], s14, v97
    s_nop 0
    s_cmp_lg_u64 s[84:85], 0
    s_cbranch_scc0 POLLOK5
    s_sleep 4
    s_add_u32 s97, s97, 1
    s_cmp_gt_u32 s97, 0x40000
    s_cbranch_scc1 K_END
    buffer_load_dword v97, v96, s[36:39], 0 offen sc1
    s_waitcnt vmcnt(0)
    s_branch POLL5
POLLOK5:
    buffer_load_dwordx4 v[16:19], v15, s[32:35], s56 offen offset:0 sc1
    buffer_load_dwordx4 v[32:35], v15, s[32:35], s56 offen offset:256 sc1
    buffer_load_dwordx4 v[20:23], v15, s[32:35], s56 offen offset:2048 sc1
    buffer_load_dwordx4 v[36:39], v15, s[32:35], s56 offen offset:2304 sc1
    buffer_load_dwordx4 v[24:27], v15, s[32:35], s57 offen offset:0 sc1
    buffer_load_dwordx4 v[40:43], v15, s[32:35], s57 offen offset:256 sc1
    buffer_load_dwordx4 v[28:31], v15, s[32:35], s57 offen offset:2048 sc1
    buffer_load_dwordx4 v[44:47], v15, s[32:35], s57 offen offset:2304 sc1
    buffer_load_dwordx4 v[120:123], v10, s[72:75], s54 offen offset:0 sc1
    buffer_load_dwordx4 v[124:127], v10, s[72:75], s54 offen offset:1024 sc1
    buffer_load_dwordx4 v[104:107], v15, s[76:79], s45 offen offset:0 sc1
    buffer_load_dwordx4 v[108:111], v15, s[76:79], s45 offen offset:256 sc1
    s_waitcnt vmcnt(4)
    s_lshl_b32 s46, s43, 4
    v_bfe_u32 v16, v16, s46, 16
    v_bfe_u32 v17, v17, s46, 16
    v_bfe_u32 v18, v18, s46, 16
    v_bfe_u32 v19, v19, s46, 16
    v_bfe_u32 v20, v20, s46, 16
    v_bfe_u32 v21, v21, s46, 16
    v_bfe_u32 v22, v22, s46, 16
    v_bfe_u32 v23, v23, s46, 16
    v_bfe_u32 v24, v24, s46, 16
    v_bfe_u32 v25, v25, s46, 16
    v_bfe_u32 v26, v26, s46, 16
    v_bfe_u32 v27, v27, s46, 16
    v_bfe_u32 v28, v28, s46, 16
    v_bfe_u32 v29, v29, s46, 16
    v_bfe_u32 v30, v30, s46, 16
    v_bfe_u32 v31, v31, s46, 16
    v_bfe_u32 v32, v32, s46, 16
    v_bfe_u32 v33, v33, s46, 16
    v_bfe_u32 v34, v34, s46, 16
    v_bfe_u32 v35, v35, s46, 16
    v_bfe_u32 v36, v36, s46, 16
    v_bfe_u32 v37, v37, s46, 16
    v_bfe_u32 v38, v38, s46, 16
    v_bfe_u32 v39, v39, s46, 16
    v_bfe_u32 v40, v40, s46, 16
    v_bfe_u32 v41, v41, s46, 16
    v_bfe_u32 v42, v42, s46, 16
    v_bfe_u32 v43, v43, s46, 16
    v_bfe_u32 v44, v44, s46, 16
    v_bfe_u32 v45, v45, s46, 16
    v_bfe_u32 v46, v46, s46, 16
    v_bfe_u32 v47, v47, s46, 16
    v_accvgpr_write_b32 a0, v16
    v_accvgpr_write_b32 a1, v17
    v_accvgpr_write_b32 a2, v18
    v_accvgpr_write_b32 a3, v19
    v_accvgpr_write_b32 a4, v20
    v_accvgpr_write_b32 a5, v21
    v_accvgpr_write_b32 a6, v22
    v_accvgpr_write_b32 a7, v23
    v_accvgpr_write_b32 a8, v24
    v_accvgpr_write_b32 a9, v25
    v_accvgpr_write_b32 a10, v26
    v_accvgpr_write_b32 a11, v27
    v_accvgpr_write_b32 a12, v28
    v_accvgpr_write_b32 a13, v29
    v_accvgpr_write_b32 a14, v30
    v_accvgpr_write_b32 a15, v31
    v_accvgpr_write_b32 a16, v32
    v_accvgpr_write_b32 a17, v33
    v_accvgpr_write_b32 a18, v34
    v_accvgpr_write_b32 a19, v35
    v_accvgpr_write_b32 a20, v36
    v_accvgpr_write_b32 a21, v37
    v_accvgpr_write_b32 a22, v38
    v_accvgpr_write_b32 a23, v39
    v_accvgpr_write_b32 a24, v40
    v_accvgpr_write_b32 a25, v41
    v_accvgpr_write_b32 a26, v42
    v_accvgpr_write_b32 a27, v43
    v_accvgpr_write_b32 a28, v44
    v_accvgpr_write_b32 a29, v45
    v_accvgpr_write_b32 a30, v46
    v_accvgpr_write_b32 a31, v47
    v_mfma_f32_16x16x32_bf16 v[16:19], a[0:3], a[64:67], 0
    v_mfma_f32_16x16x32_bf16 v[24:27], a[0:3], a[80:83], 0
    v_mfma_f32_16x16x32_bf16 v[20:23], a[16:19], a[64:67], 0
    v_mfma_f32_16x16x32_bf16 v[28:31], a[16:19], a[80:83], 0
    v_mfma_f32_16x16x32_bf16 v[16:19], a[4:7], a[68:71], v[16:19]
    v_mfma_f32_16x16x32_bf16 v[24:27], a[4:7], a[84:87], v[24:27]
    v_mfma_f32_16x16x32_bf16 v[20:23], a[20:23], a[68:71], v[20:23]
    v_mfma_f32_16x16x32_bf16 v[28:31], a[20:23], a[84:87], v[28:31]
    v_mfma_f32_16x16x32_bf16 v[16:19], a[8:11], a[72:75], v[16:19]
    v_mfma_f32_16x16x32_bf16 v[24:27], a[8:11], a[88:91], v[24:27]
    v_mfma_f32_16x16x32_bf16 v[20:23], a[24:27], a[72:75], v[20:23]
    v_mfma_f32_16x16x32_bf16 v[28:31], a[24:27], a[88:91], v[28:31]
    v_mfma_f32_16x16x32_bf16 v[16:19], a[12:15], a[76:79], v[16:19]
    v_mfma_f32_16x16x32_bf16 v[24:27], a[12:15], a[92:95], v[24:27]
    v_mfma_f32_16x16x32_bf16 v[20:23], a[28:31], a[76:79], v[20:23]
    v_mfma_f32_16x16x32_bf16 v[28:31], a[28:31], a[92:95], v[28:31]
    s_nop 4
    v_pk_mul_f32 v[32:33], v[16:17], v[64:65]
    v_pk_mul_f32 v[40:41], v[16:17], v[72:73]
    v_pk_mul_f32 v[34:35], v[18:19], v[66:67]
    v_pk_mul_f32 v[42:43], v[18:19], v[74:75]
    v_pk_mul_f32 v[36:37], v[20:21], v[68:69]
    v_pk_mul_f32 v[44:45], v[20:21], v[76:77]
    v_pk_mul_f32 v[38:39], v[22:23], v[70:71]
    v_pk_mul_f32 v[46:47], v[22:23], v[78:79]
    v_pk_fma_f32 v[32:33], v[24:25], v[72:73], v[32:33] neg_lo:[1,0,0] neg_hi:[1,0,0]
    v_pk_fma_f32 v[40:41], v[24:25], v[64:65], v[40:41]
    v_pk_fma_f32 v[34:35], v[26:27], v[74:75], v[34:35] neg_lo:[1,0,0] neg_hi:[1,0,0]
    v_pk_fma_f32 v[42:43], v[26:27], v[66:67], v[42:43]
    v_pk_fma_f32 v[36:37], v[28:29], v[76:77], v[36:37] neg_lo:[1,0,0] neg_hi:[1,0,0]
    v_pk_fma_f32 v[44:45], v[28:29], v[68:69], v[44:45]
    v_pk_fma_f32 v[38:39], v[30:31], v[78:79], v[38:39] neg_lo:[1,0,0] neg_hi:[1,0,0]
    v_pk_fma_f32 v[46:47], v[30:31], v[70:71], v[46:47]
    v_cvt_pk_bf16_f32 v48, v32, v40
    v_cvt_pk_bf16_f32 v49, v33, v41
    v_cvt_pk_bf16_f32 v50, v34, v42
    v_cvt_pk_bf16_f32 v51, v35, v43
    v_cvt_pk_bf16_f32 v52, v36, v44
    v_cvt_pk_bf16_f32 v53, v37, v45
    v_cvt_pk_bf16_f32 v54, v38, v46
    v_cvt_pk_bf16_f32 v55, v39, v47
    s_waitcnt vmcnt(2)
    v_mfma_f32_16x16x32_bf16 v[56:59], a[96:99], v[48:51], 0
    v_lshlrev_b32 v64, 16, v120
    v_and_b32 v72, 0xffff0000, v120
    v_mfma_f32_16x16x32_bf16 v[96:99], v[128:131], v[48:51], 0
    v_lshlrev_b32 v65, 16, v121
    v_and_b32 v73, 0xffff0000, v121
    v_mfma_f32_16x16x32_bf16 v[60:63], a[104:107], v[48:51], 0
    v_lshlrev_b32 v66, 16, v122
    v_and_b32 v74, 0xffff0000, v122
    v_mfma_f32_16x16x32_bf16 v[100:103], v[136:139], v[48:51], 0
    v_lshlrev_b32 v67, 16, v123
    v_and_b32 v75, 0xffff0000, v123
    v_mfma_f32_16x16x32_bf16 v[56:59], a[100:103], v[52:55], v[56:59]
    v_lshlrev_b32 v68, 16, v124
    v_and_b32 v76, 0xffff0000, v124
    v_mfma_f32_16x16x32_bf16 v[96:99], v[132:135], v[52:55], v[96:99]
    v_lshlrev_b32 v69, 16, v125
    v_and_b32 v77, 0xffff0000, v125
    v_mfma_f32_16x16x32_bf16 v[60:63], a[108:111], v[52:55], v[60:63]
    v_lshlrev_b32 v70, 16, v126
    v_and_b32 v78, 0xffff0000, v126
    v_mfma_f32_16x16x32_bf16 v[100:103], v[140:143], v[52:55], v[100:103]
    v_lshlrev_b32 v71, 16, v127
    v_and_b32 v79, 0xffff0000, v127
    v_pk_mul_f32 v[32:33], v[56:57], v[64:65]
    v_pk_mul_f32 v[40:41], v[56:57], v[72:73]
    v_pk_mul_f32 v[34:35], v[58:59], v[66:67]
    v_pk_mul_f32 v[42:43], v[58:59], v[74:75]
    v_pk_mul_f32 v[36:37], v[60:61], v[68:69]
    v_pk_mul_f32 v[44:45], v[60:61], v[76:77]
    v_pk_mul_f32 v[38:39], v[62:63], v[70:71]
    v_pk_mul_f32 v[46:47], v[62:63], v[78:79]
    v_pk_fma_f32 v[32:33], v[96:97], v[72:73], v[32:33] neg_lo:[1,0,0] neg_hi:[1,0,0]
    v_pk_fma_f32 v[40:41], v[96:97], v[64:65], v[40:41]
    v_pk_fma_f32 v[34:35], v[98:99], v[74:75], v[34:35] neg_lo:[1,0,0] neg_hi:[1,0,0]
    v_pk_fma_f32 v[42:43], v[98:99], v[66:67], v[42:43]
    v_pk_fma_f32 v[36:37], v[100:101], v[76:77], v[36:37] neg_lo:[1,0,0] neg_hi:[1,0,0]
    v_pk_fma_f32 v[44:45], v[100:101], v[68:69], v[44:45]
    v_pk_fma_f32 v[38:39], v[102:103], v[78:79], v[38:39] neg_lo:[1,0,0] neg_hi:[1,0,0]
    v_pk_fma_f32 v[46:47], v[102:103], v[70:71], v[46:47]
    v_cvt_pk_bf16_f32 v48, v32, -v40
    v_cvt_pk_bf16_f32 v49, v33, -v41
    v_cvt_pk_bf16_f32 v50, v34, -v42
    v_cvt_pk_bf16_f32 v51, v35, -v43
    v_cvt_pk_bf16_f32 v52, v36, -v44
    v_cvt_pk_bf16_f32 v53, v37, -v45
    v_cvt_pk_bf16_f32 v54, v38, -v46
    v_cvt_pk_bf16_f32 v55, v39, -v47
    v_mfma_f32_16x16x32_bf16 v[16:19], v[48:51], a[96:99], 0
    v_mfma_f32_16x16x32_bf16 v[24:27], v[48:51], v[128:131], 0
    v_mfma_f32_16x16x32_bf16 v[20:23], v[48:51], a[104:107], 0
    v_mfma_f32_16x16x32_bf16 v[28:31], v[48:51], v[136:139], 0
    v_mfma_f32_16x16x32_bf16 v[16:19], v[52:55], a[100:103], v[16:19]
    v_mfma_f32_16x16x32_bf16 v[24:27], v[52:55], v[132:135], v[24:27]
    v_mfma_f32_16x16x32_bf16 v[20:23], v[52:55], a[108:111], v[20:23]
    v_mfma_f32_16x16x32_bf16 v[28:31], v[52:55], v[140:143], v[28:31]
    v_lshlrev_b32 v3, 4, v0
    s_nop 3
    v_pk_mul_f32 v[32:33], v[16:17], v[80:81]
    v_pk_mul_f32 v[40:41], v[16:17], v[88:89]
    v_pk_mul_f32 v[34:35], v[18:19], v[82:83]
    v_pk_mul_f32 v[42:43], v[18:19], v[90:91]
    v_pk_mul_f32 v[36:37], v[20:21], v[84:85]
    v_pk_mul_f32 v[44:45], v[20:21], v[92:93]
    v_pk_mul_f32 v[38:39], v[22:23], v[86:87]
    v_pk_mul_f32 v[46:47], v[22:23], v[94:95]
    v_pk_fma_f32 v[32:33], v[24:25], v[88:89], v[32:33] neg_lo:[1,0,0] neg_hi:[1,0,0]
    v_pk_fma_f32 v[40:41], v[24:25], v[80:81], v[40:41]
    v_pk_fma_f32 v[34:35], v[26:27], v[90:91], v[34:35] neg_lo:[1,0,0] neg_hi:[1,0,0]
    v_pk_fma_f32 v[42:43], v[26:27], v[82:83], v[42:43]
    v_pk_fma_f32 v[36:37], v[28:29], v[92:93], v[36:37] neg_lo:[1,0,0] neg_hi:[1,0,0]
    v_pk_fma_f32 v[44:45], v[28:29], v[84:85], v[44:45]
    v_pk_fma_f32 v[38:39], v[30:31], v[94:95], v[38:39] neg_lo:[1,0,0] neg_hi:[1,0,0]
    v_pk_fma_f32 v[46:47], v[30:31], v[86:87], v[46:47]
    v_cvt_pk_bf16_f32 v48, v32, v40
    v_cvt_pk_bf16_f32 v49, v33, v41
    v_cvt_pk_bf16_f32 v50, v34, v42
    v_cvt_pk_bf16_f32 v51, v35, v43
    v_cvt_pk_bf16_f32 v52, v36, v44
    v_cvt_pk_bf16_f32 v53, v37, v45
    v_cvt_pk_bf16_f32 v54, v38, v46
    v_cvt_pk_bf16_f32 v55, v39, v47
    ds_write_b128 v3, v[48:51] offset:0
    ds_write_b128 v3, v[52:55] offset:4096
    s_waitcnt lgkmcnt(0)
    s_barrier
    ds_read_b128 a[0:3], v10 offset:0
    ds_read_b128 a[16:19], v10 offset:4096
    ds_read_b128 a[4:7], v10 offset:1024
    ds_read_b128 a[20:23], v10 offset:5120
    ds_read_b128 a[8:11], v10 offset:2048
    ds_read_b128 a[24:27], v10 offset:6144
    ds_read_b128 a[12:15], v10 offset:3072
    ds_read_b128 a[28:31], v10 offset:7168
    s_waitcnt lgkmcnt(6)
    v_mfma_f32_16x16x32_bf16 v[56:59], a[64:67], a[0:3], 0
    v_mfma_f32_16x16x32_bf16 v[96:99], a[80:83], a[0:3], 0
    v_mfma_f32_16x16x32_bf16 v[60:63], a[64:67], a[16:19], 0
    v_mfma_f32_16x16x32_bf16 v[100:103], a[80:83], a[16:19], 0
    s_waitcnt lgkmcnt(4)
    v_mfma_f32_16x16x32_bf16 v[56:59], a[68:71], a[4:7], v[56:59]
    v_mfma_f32_16x16x32_bf16 v[96:99], a[84:87], a[4:7], v[96:99]
    v_mfma_f32_16x16x32_bf16 v[60:63], a[68:71], a[20:23], v[60:63]
    v_mfma_f32_16x16x32_bf16 v[100:103], a[84:87], a[20:23], v[100:103]
    s_waitcnt lgkmcnt(2)
    v_mfma_f32_16x16x32_bf16 v[56:59], a[72:75], a[8:11], v[56:59]
    v_mfma_f32_16x16x32_bf16 v[96:99], a[88:91], a[8:11], v[96:99]
    v_mfma_f32_16x16x32_bf16 v[60:63], a[72:75], a[24:27], v[60:63]
    v_mfma_f32_16x16x32_bf16 v[100:103], a[88:91], a[24:27], v[100:103]
    s_waitcnt lgkmcnt(0)
    v_mfma_f32_16x16x32_bf16 v[56:59], a[76:79], a[12:15], v[56:59]
    v_mfma_f32_16x16x32_bf16 v[96:99], a[92:95], a[12:15], v[96:99]
    v_mfma_f32_16x16x32_bf16 v[60:63], a[76:79], a[28:31], v[60:63]
    v_mfma_f32_16x16x32_bf16 v[100:103], a[92:95], a[28:31], v[100:103]
    s_waitcnt vmcnt(0)
    s_nop 3
    v_pk_mul_f32 v[56:57], v[56:57], v[104:105]
    v_pk_mul_f32 v[96:97], v[96:97], v[104:105]
    v_pk_mul_f32 v[58:59], v[58:59], v[106:107]
    v_pk_mul_f32 v[98:99], v[98:99], v[106:107]
    v_pk_mul_f32 v[60:61], v[60:61], v[108:109]
    v_pk_mul_f32 v[100:101], v[100:101], v[108:109]
    v_pk_mul_f32 v[62:63], v[62:63], v[110:111]
    v_pk_mul_f32 v[102:103], v[102:103], v[110:111]
    v_cvt_pk_bf16_f32 v48, v56, v96
    v_cvt_pk_bf16_f32 v49, v57, v97
    v_cvt_pk_bf16_f32 v50, v58, v98
    v_cvt_pk_bf16_f32 v51, v59, v99
    v_cvt_pk_bf16_f32 v52, v60, v100
    v_cvt_pk_bf16_f32 v53, v61, v101
    v_cvt_pk_bf16_f32 v54, v62, v102
    v_cvt_pk_bf16_f32 v55, v63, v103
    buffer_store_dwordx4 v[48:51], v15, s[68:71], s54 offen offset:0 sc1
    buffer_store_dwordx4 v[52:55], v15, s[68:71], s54 offen offset:256 sc1
    s_waitcnt vmcnt(0)
    s_lshl_b32 s96, s40, 15
    s_lshl_b32 s95, s52, 5
    s_add_u32 s96, s96, s95
    s_add_u32 s96, s96, 327680
    s_mov_b64 exec, 1
    buffer_store_dword v13, v11, s[36:39], s96 offen sc1
    s_mov_b64 exec, -1
K_HFIN:
K_END:
    s_endpgm
.section .rodata,"a"
.p2align 6
.amdhsa_kernel gated_mix__spectral_gfnet__dense_activation_gelu__prompt_kernel
  .amdhsa_next_free_vgpr 256
  .amdhsa_next_free_sgpr 102
  .amdhsa_accum_offset 144
  .amdhsa_group_segment_fixed_size 0
  .amdhsa_kernarg_size 96
  .amdhsa_user_sgpr_count 2
  .amdhsa_user_sgpr_kernarg_segment_ptr 1
  .amdhsa_system_sgpr_workgroup_id_x 1
  .amdhsa_float_denorm_mode_32 3
.end_amdhsa_kernel
```
